```python
import torch

def _softmax(x, axis=-1):
    return torch.softmax(x, dim=axis)
def _gelu(x):
    return torch.nn.functional.gelu(x, approximate="tanh")
def _silu(x):
    return torch.nn.functional.silu(x)
def _sigmoid(x):
    return torch.sigmoid(x)
def _layernorm(x, axis=-1, eps=1e-5):
    m = x.mean(dim=axis, keepdim=True)
    v = x.var(dim=axis, keepdim=True, unbiased=False)
    return (x - m) / torch.sqrt(v + eps)
def _scatter_add(tgt, idx, src, axis=0):
    return tgt.clone().index_add_(axis, idx, src)
def _segment_sum(src, seg, n):
    out = torch.zeros((n,) + src.shape[1:], dtype=src.dtype)
    return out.index_add_(0, seg, src)
def _pad(x, pw):
    flat = tuple(v for pair in reversed(pw) for v in pair)
    return torch.nn.functional.pad(x, flat)

kernel_name = 'standalone__window_attn_swin_v2__vision'

def setup_inputs():

    _w = (lambda a: (lambda t: t.to(torch.bfloat16) if t.is_floating_point() else t)(torch.as_tensor(a)))
    win = 7
    H = W = (384 // win) * win
    C = 96
    nh = 4
    shift = win // 2
    coords = torch.stack(torch.meshgrid(torch.arange(win), torch.arange(win), indexing="ij"), -1).reshape(-1, 2)
    rel = coords[:, None, :] - coords[None, :, :]
    rel_idx = ((rel[..., 0] + win - 1) * (2 * win - 1) + (rel[..., 1] + win - 1)).to(torch.int64)
    tab = torch.stack(torch.meshgrid(torch.arange(1 - win, win), torch.arange(1 - win, win), indexing="ij"), -1).reshape(-1, 2).to(float)
    tab = (lambda _x: torch.sign(torch.as_tensor(_x)))(tab) * (lambda _x: torch.log1p(torch.as_tensor(_x)))(torch.abs(tab))
    img = torch.zeros((H, W), dtype=torch.int64)
    cnt = 0
    for hs in (slice(0, H - win), slice(H - win, H - shift), slice(H - shift, H)):
        for ws in (slice(0, W - win), slice(W - win, W - shift), slice(W - shift, W)):
            img[hs, ws] = cnt; cnt += 1
    mw = img.reshape(H // win, win, W // win, win).permute(0, 2, 1, 3).reshape(-1, win * win)
    mask = (mw[:, :, None] != mw[:, None, :]).to(float) * (-100.0)
    return {
        "x": _w((lambda *s: torch.randn(*s, dtype=torch.bfloat16) * 0.05)(1, H, W, C)),
        "wqkv": _w((lambda *s: torch.randn(*s, dtype=torch.bfloat16) * 0.8)(C, 3 * C)),
        "wo": _w((lambda *s: torch.randn(*s, dtype=torch.bfloat16) * 0.05)(C, C)),
        "logit_scale": _w((lambda *s: torch.randn(*s, dtype=torch.bfloat16) * 0.8)(nh)),
        "cpb_w1": _w((lambda *s: torch.randn(*s, dtype=torch.bfloat16) * 0.8)(2, 4 * nh)),
        "cpb_w2": _w((lambda *s: torch.randn(*s, dtype=torch.bfloat16) * 0.8)(4 * nh, nh)),
        "rel_coords": _w(tab),
        "rel_idx": _w(rel_idx),
        "attn_mask": _w(mask),
    }

def reference(x, wqkv, wo, logit_scale, cpb_w1, cpb_w2, rel_coords, rel_idx, attn_mask):
    B, H, W, C = x.shape
    win = 7
    nh = 4
    hd = C // nh
    shift = win // 2
    ww = win * win
    nH, nW = H // win, W // win
    xs = torch.roll(x, (-shift, -shift), (1, 2))
    xw = (lambda x, *d: x.permute(*d))(xs.reshape(B, nH, win, nW, win, C), 0, 1, 3, 2, 4, 5).reshape(B * nH * nW, ww, C)
    qkv = (lambda x, *d: x.permute(*d))((xw @ wqkv).reshape(B * nH * nW, ww, 3, nh, hd), 2, 0, 3, 1, 4)
    q, k, v = qkv[0], qkv[1], qkv[2]
    qn = q * (torch.einsum("bhqd,bhqd->bhq", q, q)[..., None] + 1e-12) ** -0.5
    kn = k * (torch.einsum("bhkd,bhkd->bhk", k, k)[..., None] + 1e-12) ** -0.5
    logits = torch.einsum("bhqd,bhkd->bhqk", qn, kn)
    tau = torch.exp(torch.clip(logit_scale, -100.0, 4.6052))
    logits = logits * tau[None, :, None, None]
    hcpb = rel_coords @ cpb_w1
    hcpb = torch.where(hcpb > 0, hcpb, hcpb * 0)
    bias_tab = 16.0 * _sigmoid(hcpb @ cpb_w2)
    bias = (lambda x, *d: x.permute(*d))(bias_tab[rel_idx], 2, 0, 1)
    logits = logits.reshape(B, nH * nW, nh, ww, ww) + bias[None, None, :, :, :] + attn_mask[None, :, None, :, :]
    p = _softmax(logits.reshape(B * nH * nW, nh, ww, ww), axis=-1)
    o = (lambda x, *d: x.permute(*d))(torch.einsum("bhqk,bhkd->bhqd", p, v), 0, 2, 1, 3).reshape(B * nH * nW, ww, C) @ wo
    o = (lambda x, *d: x.permute(*d))(o.reshape(B, nH, nW, win, win, C), 0, 1, 3, 2, 4, 5).reshape(B, H, W, C)
    o = torch.roll(o, (shift, shift), (1, 2))
    return _layernorm(o, axis=-1)
```

```asm
; @launch grid=(243,1,1) block=(512,1,1) lds=160448
.amdgcn_target "amdgcn-amd-amdhsa--gfx950"
.text
.globl standalone__window_attn_swin_v2__vision_kernel
.p2align 8
.type standalone__window_attn_swin_v2__vision_kernel,@function
standalone__window_attn_swin_v2__vision_kernel:
    s_cmp_ge_u32 s2, 243
    s_cbranch_scc1 L_end
    s_load_dwordx16 s[52:67], s[0:1], 0x0
    s_load_dwordx2 s[68:69], s[0:1], 0x48
    v_lshrrev_b32 v1, 6, v0
    v_and_b32 v254, 63, v0
    v_readfirstlane_b32 s74, v1
    v_and_b32 v255, 15, v254
    s_and_b32 s16, s74, 3
    s_lshr_b32 s75, s74, 2
    s_lshl_b32 s2, s2, 1
    s_add_u32 s2, s2, s75
    v_lshrrev_b32 v162, 4, v254
    v_lshlrev_b32 v163, 4, v254
    v_and_b32 v164, 3, v254
    v_lshrrev_b32 v165, 2, v255
    v_and_b32 v166, 48, v254
    v_min_u32 v10, 168, v0
    v_lshlrev_b32 v10, 2, v10
    v_lshlrev_b32 v11, 1, v255
    v_lshlrev_b32 v12, 1, v166
    v_lshl_add_u32 v12, v164, 1, v12
    s_mul_i32 s17, s2, 7282
    s_lshr_b32 s17, s17, 16
    s_mul_i32 s22, s17, 9
    s_sub_u32 s18, s2, s22
    s_mul_i32 s18, s18, 42
    s_mul_i32 s17, s17, 7
    s_lshl_b32 s22, s16, 4
    v_add_u32 v2, s22, v255
    v_mul_u32_u24 v3, 37, v2
    v_lshrrev_b32 v3, 8, v3
    v_mul_u32_u24 v4, 7, v3
    v_sub_u32 v4, v2, v4
    s_add_u32 s22, s17, 3
    v_add_u32 v5, s22, v3
    v_subrev_u32 v3, 378, v5
    v_min_u32 v5, v5, v3
    v_mul_u32_u24 v5, 378, v5
    v_add_u32 v8, v5, v4
    v_mul_u32_u24 v8, 192, v8
    v_add_u32 v8, v8, v166
    s_add_u32 s20, s18, 3
    s_mul_i32 s20, s20, 192
    s_mul_i32 s36, s75, 27648
    s_add_u32 s36, s36, 77568
    s_add_u32 s22, s17, 9
    s_sub_u32 s23, s22, 378
    s_min_u32 s22, s22, s23
    s_mul_i32 s22, s22, 378
    s_add_u32 s23, s18, 9
    v_mul_u32_u24 v6, 7, v255
    v_add_u32 v6, s23, v6
    v_subrev_u32 v3, 378, v6
    v_min_u32 v6, v6, v3
    v_add_u32 v7, s22, v6
    v_mul_u32_u24 v7, 192, v7
    v_add_u32 v7, v7, v166
    s_mov_b32 exec_lo, 0xffc0ffc0
    s_mov_b32 exec_hi, 0xffc0ffc0
    v_mov_b32 v7, 0x40000000
    s_mov_b64 exec, -1
    s_lshr_b32 s22, s2, 4
    s_mul_i32 s23, s22, 37
    s_lshr_b32 s23, s23, 8
    s_mul_i32 s23, s23, 7
    s_sub_u32 s22, s22, s23
    s_lshl_b32 s22, s22, 3
    s_add_u32 s22, s22, s74
    s_lshl_b32 s22, s22, 10
    s_sub_u32 s23, s22, 56320
    s_min_u32 m0, s22, s23
    v_mov_b32 v33, -32
    v_add_u32 v30, m0, v163
    v_mul_u32_u24 v32, 14464, v30
    v_lshrrev_b32 v32, 26, v32
    v_mad_i32_i24 v30, v32, v33, v30
    s_mul_i32 s38, s16, 3072
    s_add_u32 s38, s38, s36
    s_mul_i32 s22, s75, 3072
    s_add_u32 s41, s22, 154304
    s_cmp_eq_u32 s16, 3
    s_cselect_b32 s38, s41, s38
    s_cselect_b32 s39, 0, s20
    s_cselect_b64 s[44:45], -1, 0
    v_cndmask_b32_e64 v8, v8, v7, s[44:45]
    s_lshl_b32 s22, s16, 1
    s_add_u32 s22, s22, s75
    s_lshl_b32 s22, s22, 2
    s_sub_u32 s22, s22, 8
    s_max_i32 s22, s22, 0
    v_add_u32 v24, s22, v164
    v_mul_u32_u24 v25, 43, v24
    v_lshrrev_b32 v25, 8, v25
    v_mul_u32_u24 v26, 6, v25
    v_sub_u32 v26, v24, v26
    v_and_b32 v27, 1, v25
    v_lshl_add_u32 v26, v27, 2, v26
    v_subrev_u32 v27, 6, v26
    v_min_u32 v26, v26, v27
    v_cmp_gt_u32 s[44:45], 4, v26
    v_lshl_add_u32 v27, v165, 2, v26
    v_lshl_add_u32 v28, v165, 1, v26
    v_add_u32 v28, 12, v28
    v_cndmask_b32_e64 v27, v28, v27, s[44:45]
    v_mad_u32_u24 v27, v25, 24, v27
    v_mul_u32_u24 v27, 192, v27
    v_add_u32 v27, v27, v166
    s_waitcnt lgkmcnt(0)
    s_mov_b32 s12, s54
    s_and_b32 s13, s55, 0xffff
    s_mov_b32 s14, 0xd800
    s_mov_b32 s15, 0x00020000
    s_cmp_ge_u32 s74, 3
    s_cbranch_scc1 L_skipsm
    global_load_dword v13, v10, s[64:65]
    global_load_ushort v18, v11, s[60:61]
    global_load_ushort v19, v11, s[60:61] offset:32
    global_load_ushort v20, v12, s[62:63]
    global_load_ushort v21, v12, s[62:63] offset:8
    global_load_ushort v22, v12, s[62:63] offset:16
    global_load_ushort v1, v12, s[62:63] offset:24
L_skipsm:
    s_load_dwordx2 s[70:71], s[58:59], 0x0
    buffer_load_dwordx4 v30, s[12:15], 0 offen lds
    s_add_u32 s46, m0, 8192
    s_sub_u32 s47, s46, 56320
    s_min_u32 m0, s46, s47
    v_add_u32 v31, m0, v163
    v_mul_u32_u24 v32, 14464, v31
    v_lshrrev_b32 v32, 26, v32
    v_mad_i32_i24 v31, v32, v33, v31
    s_mov_b32 s4, s52
    s_and_b32 s5, s53, 0xffff
    s_mov_b32 s6, 0x1a29b00
    s_mov_b32 s7, 0x00020000
    s_lshl_b32 s76, s75, 11
    s_add_u32 s76, s76, 150144
    buffer_load_dwordx4 v31, s[12:15], 0 offen lds
    s_add_u32 s46, m0, 8192
    s_sub_u32 s47, s46, 56320
    s_min_u32 m0, s46, s47
    v_add_u32 v30, m0, v163
    v_mul_u32_u24 v32, 14464, v30
    v_lshrrev_b32 v32, 26, v32
    v_mad_i32_i24 v30, v32, v33, v30
    s_add_u32 s22, s18, 38
    v_add_u32 v6, s22, v4
    v_subrev_u32 v3, 378, v6
    v_min_u32 v6, v6, v3
    v_add_u32 v9, v5, v6
    v_mul_u32_u24 v9, 192, v9
    v_add_u32 v9, v9, v166
    buffer_load_dwordx4 v30, s[12:15], 0 offen lds
    s_add_u32 s46, m0, 8192
    s_sub_u32 s47, s46, 56320
    s_min_u32 m0, s46, s47
    v_add_u32 v31, m0, v163
    v_mul_u32_u24 v32, 14464, v31
    v_lshrrev_b32 v32, 26, v32
    v_mad_i32_i24 v31, v32, v33, v31
    s_lshl_b32 s22, s16, 8
    s_add_u32 s22, s22, s76
    v_lshl_add_u32 v2, v254, 2, s22
    ds_write_b32 v2, v9 offset:1024
    ds_write_b32 v2, v8
    v_mul_u32_u24 v99, 48, v254
    v_mov_b32 v254, v8
    v_add_u32 v253, s41, v163
    v_add_u32 v110, 59136, v163
    buffer_load_dwordx4 v31, s[12:15], 0 offen lds
    s_add_u32 s46, m0, 8192
    s_sub_u32 s47, s46, 56320
    s_min_u32 m0, s46, s47
    v_add_u32 v30, m0, v163
    v_mul_u32_u24 v32, 14464, v30
    v_lshrrev_b32 v32, 26, v32
    v_mad_i32_i24 v30, v32, v33, v30
    s_mul_i32 s22, s16, 48
    v_lshl_add_u32 v175, v162, 3, v165
    v_mul_u32_u24 v175, 576, v175
    v_lshl_add_u32 v175, v164, 3, v175
    v_lshl_add_u32 v175, v162, 5, v175
    v_add_u32 v175, s22, v175
    buffer_load_dwordx4 v30, s[12:15], 0 offen lds
    s_add_u32 s46, m0, 8192
    s_sub_u32 s47, s46, 56320
    s_min_u32 m0, s46, s47
    v_add_u32 v31, m0, v163
    v_mul_u32_u24 v32, 14464, v31
    v_lshrrev_b32 v32, 26, v32
    v_mad_i32_i24 v31, v32, v33, v31
    v_lshl_add_u32 v176, v165, 3, v164
    v_mul_u32_u24 v176, 576, v176
    v_lshl_add_u32 v176, v165, 5, v176
    v_min_u32 v29, 2, v162
    v_mul_u32_u24 v29, 192, v29
    s_add_u32 s22, s22, 32
    v_add3_u32 v176, v176, v29, s22
    buffer_load_dwordx4 v31, s[12:15], 0 offen lds
    s_add_u32 s46, m0, 8192
    s_sub_u32 s47, s46, 56320
    s_min_u32 m0, s46, s47
    v_add_u32 v30, m0, v163
    v_mul_u32_u24 v32, 14464, v30
    v_lshrrev_b32 v32, 26, v32
    v_mad_i32_i24 v30, v32, v33, v30
    v_mov_b32 v218, 0
    v_mov_b32 v219, 0
    v_mov_b32 v220, 0
    v_mov_b32 v221, 0
    buffer_load_dwordx4 v30, s[12:15], 0 offen lds
    s_mov_b32 m0, s38
    global_load_dwordx4 v[222:225], v27, s[56:57]
    global_load_dwordx4 v[226:229], v27, s[56:57] offset:64
    global_load_dwordx4 v[230:233], v27, s[56:57] offset:128
    s_barrier
    buffer_load_dwordx4 v254, s[4:7], s39 offen lds
    s_add_u32 m0, m0, 1024
    s_add_u32 s39, s39, 64
    v_mov_b32 v40, 0x3f803f80
    v_mov_b32 v167, 0x3f80
    s_mov_b32 exec_lo, 0xaaaaaaaa
    s_mov_b32 exec_hi, 0xaaaaaaaa
    v_mov_b32 v167, 0x3f800000
    s_mov_b64 exec, -1
    s_mov_b32 s44, 0xc0003
    s_mov_b32 s45, 0x0
    v_cndmask_b32_e64 v146, 0, v167, s[44:45]
    s_mov_b32 s44, 0x0
    s_mov_b32 s45, 0x3
    v_cndmask_b32_e64 v170, 0, v167, s[44:45]
    buffer_load_dwordx4 v254, s[4:7], s39 offen lds
    s_add_u32 m0, m0, 1024
    s_add_u32 s39, s39, 64
    s_mov_b32 s44, 0xc00030
    s_mov_b32 s45, 0x0
    v_cndmask_b32_e64 v147, 0, v167, s[44:45]
    s_mov_b32 s44, 0x0
    s_mov_b32 s45, 0x30
    v_cndmask_b32_e64 v171, 0, v167, s[44:45]
    s_mov_b32 s44, 0xc000300
    s_mov_b32 s45, 0x0
    v_cndmask_b32_e64 v148, 0, v167, s[44:45]
    s_mov_b32 s44, 0x0
    s_mov_b32 s45, 0x300
    v_cndmask_b32_e64 v172, 0, v167, s[44:45]
    buffer_load_dwordx4 v254, s[4:7], s39 offen lds
    s_mov_b32 s44, 0xc0003000
    s_mov_b32 s45, 0x0
    v_cndmask_b32_e64 v149, 0, v167, s[44:45]
    s_mov_b32 s44, 0x0
    s_mov_b32 s45, 0x3000
    v_cndmask_b32_e64 v173, 0, v167, s[44:45]
    s_mov_b32 s44, 0x300003
    s_mov_b32 s45, 0x30000300
    v_cndmask_b32_e64 v248, 0, v167, s[44:45]
    s_mov_b32 s44, 0xc0000c
    s_mov_b32 s45, 0xc0000c00
    v_cndmask_b32_e64 v249, 0, v167, s[44:45]
    v_mov_b32 v246, 0
    v_mov_b32 v247, 0
    v_mov_b32 v250, 0
    v_mov_b32 v251, 0
    s_mov_b32 s44, 0x33333333
    s_mov_b32 s45, 0x33333333
    v_cndmask_b32_e64 v112, 0, v40, s[44:45]
    s_mov_b32 s44, 0x66666666
    s_mov_b32 s45, 0x66666666
    v_cndmask_b32_e64 v113, 0, v40, s[44:45]
    s_mov_b32 s44, 0x44444444
    s_mov_b32 s45, 0x44444444
    v_cndmask_b32_e64 v154, 0, v40, s[44:45]
    v_mov_b32 v155, v154
    v_mov_b32 v156, v154
    v_mov_b32 v157, v154
    v_mov_b32 v158, v154
    v_mov_b32 v159, v154
    v_mov_b32 v153, 0
    v_mov_b32 v161, 0
    v_mov_b32 v169, 0
    v_mov_b32 v117, 0
    v_mov_b32 v133, 0
    v_mov_b32 v121, 0
    v_mov_b32 v137, 0
    v_mov_b32 v125, 0
    v_mov_b32 v141, 0
    v_mov_b32 v129, 0
    v_mov_b32 v145, 0
    s_mov_b32 s8, s68
    s_and_b32 s9, s69, 0xffff
    s_mov_b32 s10, 0x1a29b00
    s_mov_b32 s11, 0x00020000
    s_mov_b32 s24, 0x2a0cbccc
    s_mov_b32 s25, 0x387ba882
    s_mov_b32 s26, 0x33333333
    s_mov_b32 s27, 0x33333333
    s_mov_b32 s28, 0x00010001
    s_mov_b32 s29, 0x00010001
    s_mul_i32 s22, s74, 1920
    s_add_u32 s22, s22, 132864
    v_add_u32 v103, s22, v166
    v_lshlrev_b32 v41, 4, v165
    v_lshl_add_u32 v41, v164, 1, v41
    v_add_u32 v105, 148224, v41
    s_mov_b32 exec_lo, 0xffff
    s_mov_b32 exec_hi, 0x0
    v_add_u32 v105, s22, v41
    s_mov_b64 exec, -1
    v_mul_u32_u24 v168, 1280, v162
    v_add3_u32 v168, v168, v41, s22
    v_mul_u32_u24 v165, 320, v255
    v_add_u32 v165, v165, v103
    v_add_u32 v97, s36, v163
    s_lshl_b32 s22, s75, 3
    s_add_u32 s22, s22, 154240
    v_mov_b32 v107, s22
    s_mul_i32 s77, s75, 21504
    s_mul_i32 s22, s16, 12
    s_and_b32 s23, s16, 1
    s_lshl_b32 s23, s23, 2
    s_add_u32 s37, s22, s23
    s_lshl_b32 s23, s23, 1
    s_add_u32 s22, s22, 8
    s_add_u32 s22, s22, s77
    s_sub_u32 s22, s22, s23
    v_add_u32 v101, s22, v99
    s_add_u32 s22, s37, s77
    v_add_u32 v99, s22, v99
    s_lshl_b32 s22, s16, 10
    s_lshl_b32 s23, s75, 3
    s_add_u32 s22, s22, s23
    s_sub_u32 s22, s22, 1024
    s_cmp_eq_u32 s16, 0
    s_cselect_b32 s22, 0x30000, s22
    v_add_u32 v252, s22, v110
    s_mul_i32 s40, s16, 704
    s_add_u32 s40, s40, 56320
    v_mul_u32_u24 v47, 148, v162
    s_lshl_b32 s22, s40, 1
    s_add_u32 s22, s22, 672
    v_mov_b32 v108, s40
    v_mov_b32 v48, -24
    v_add_u32 v44, 0, v255
    v_mul_u32_u24 v43, 37, v44
    v_lshrrev_b32 v43, 8, v43
    v_lshl_add_u32 v44, v44, 2, s40
    v_mad_u32_u24 v96, v43, 24, v44
    v_sub_u32 v102, s22, v96
    v_sub_u32 v44, v96, v166
    v_add_u32 v45, 16, v255
    v_mul_u32_u24 v43, 37, v45
    v_lshrrev_b32 v43, 8, v43
    v_lshl_add_u32 v45, v45, 2, s40
    v_mad_u32_u24 v98, v43, 24, v45
    v_sub_u32 v104, s22, v98
    v_sub_u32 v45, v98, v166
    v_add_u32 v46, 32, v255
    v_mul_u32_u24 v43, 37, v46
    v_lshrrev_b32 v43, 8, v43
    v_lshl_add_u32 v46, v46, 2, s40
    v_mad_u32_u24 v100, v43, 24, v46
    v_sub_u32 v106, s22, v100
    v_sub_u32 v46, v100, v166
    v_add_u32 v49, 0, v47
    v_lshrrev_b32 v49, 8, v49
    v_add_u32 v50, 74, v47
    v_lshrrev_b32 v50, 8, v50
    v_add_u32 v51, 111, v47
    v_lshrrev_b32 v51, 8, v51
    v_add_u32 v52, 592, v47
    v_lshrrev_b32 v52, 8, v52
    v_add_u32 v53, 629, v47
    v_lshrrev_b32 v53, 8, v53
    v_add_u32 v54, 666, v47
    v_lshrrev_b32 v54, 8, v54
    v_add_u32 v55, 1184, v47
    v_lshrrev_b32 v55, 8, v55
    v_add_u32 v56, 1258, v47
    v_lshrrev_b32 v56, 8, v56
    v_add_u32 v57, 1295, v47
    v_lshrrev_b32 v57, 8, v57
    v_mad_i32_i24 v60, v49, v48, v44
    v_mad_i32_i24 v62, v50, v48, v44
    v_mad_i32_i24 v63, v51, v48, v44
    v_mad_i32_i24 v64, v52, v48, v44
    v_mad_i32_i24 v65, v53, v48, v44
    v_mad_i32_i24 v66, v54, v48, v44
    v_mad_i32_i24 v68, v55, v48, v44
    v_mad_i32_i24 v70, v56, v48, v44
    v_mad_i32_i24 v71, v57, v48, v44
    v_mad_i32_i24 v72, v49, v48, v45
    v_mad_i32_i24 v74, v50, v48, v45
    v_mad_i32_i24 v75, v51, v48, v45
    v_mad_i32_i24 v76, v52, v48, v45
    v_mad_i32_i24 v77, v53, v48, v45
    v_mad_i32_i24 v78, v54, v48, v45
    v_mad_i32_i24 v80, v55, v48, v45
    v_mad_i32_i24 v82, v56, v48, v45
    v_mad_i32_i24 v83, v57, v48, v45
    v_mad_i32_i24 v84, v49, v48, v46
    v_mad_i32_i24 v86, v50, v48, v46
    v_mad_i32_i24 v87, v51, v48, v46
    v_mad_i32_i24 v88, v52, v48, v46
    v_mad_i32_i24 v89, v53, v48, v46
    v_mad_i32_i24 v90, v54, v48, v46
    v_mad_i32_i24 v92, v55, v48, v46
    v_mad_i32_i24 v94, v56, v48, v46
    v_mad_i32_i24 v95, v57, v48, v46
    s_mov_b32 s19, 0
    s_mov_b32 s32, 12288
    s_add_u32 s79, s36, 18432
    s_add_u32 s73, s36, 27648
    s_mov_b32 s78, 0
    s_sub_u32 s21, s20, 1344
    s_add_u32 s20, s20, 1344
    s_cmp_eq_u32 s17, 371
    s_cselect_b32 s34, 2, 0
    s_cmp_eq_u32 s18, 336
    s_cselect_b32 s35, 1, 0
    s_mov_b32 s48, 0
    s_cmp_gt_u32 s74, 3
    s_waitcnt lgkmcnt(0)
    s_cbranch_scc1 L_skiptab
    s_cmp_eq_u32 s74, 3
    s_cbranch_scc1 L_dum
    v_mov_b32 v203, 0
    v_mov_b32 v205, 0
    v_mov_b32 v207, 0
    v_mov_b32 v209, 0
    s_waitcnt vmcnt(13)
    v_lshl_or_b32 v14, v19, 16, v18
    v_lshl_or_b32 v16, v21, 16, v20
    v_lshl_or_b32 v17, v1, 16, v22
    s_mov_b32 s44, 0xffff
    s_mov_b32 s45, 0x0
    v_cndmask_b32_e64 v202, 0, v14, s[44:45]
    s_mov_b32 s44, 0xf000f
    s_mov_b32 s45, 0xf000f
    v_cndmask_b32_e64 v210, 0, v16, s[44:45]
    v_cndmask_b32_e64 v211, 0, v17, s[44:45]
    s_mov_b32 s44, 0xffff0000
    s_mov_b32 s45, 0x0
    v_cndmask_b32_e64 v204, 0, v14, s[44:45]
    s_mov_b32 s44, 0xf000f0
    s_mov_b32 s45, 0xf000f0
    v_cndmask_b32_e64 v212, 0, v16, s[44:45]
    v_cndmask_b32_e64 v213, 0, v17, s[44:45]
    s_mov_b32 s44, 0x0
    s_mov_b32 s45, 0xffff
    v_cndmask_b32_e64 v206, 0, v14, s[44:45]
    s_mov_b32 s44, 0xf000f00
    s_mov_b32 s45, 0xf000f00
    v_cndmask_b32_e64 v214, 0, v16, s[44:45]
    v_cndmask_b32_e64 v215, 0, v17, s[44:45]
    s_mov_b32 s44, 0x0
    s_mov_b32 s45, 0xffff0000
    v_cndmask_b32_e64 v208, 0, v14, s[44:45]
    s_mov_b32 s44, 0xf000f000
    s_mov_b32 s45, 0xf000f000
    v_cndmask_b32_e64 v216, 0, v16, s[44:45]
    v_cndmask_b32_e64 v217, 0, v17, s[44:45]
    v_mov_b32 v10, v13
    v_mov_b32 v11, 0
    v_mov_b32 v12, 0xc138aa3b
    s_nop 0
    v_mfma_f32_16x16x16_bf16 v[24:27], v[202:203], v[10:11], 0
    v_mfma_f32_16x16x16_bf16 v[28:31], v[204:205], v[10:11], 0
    v_mfma_f32_16x16x16_bf16 v[32:35], v[206:207], v[10:11], 0
    s_nop 5
    v_cvt_pk_bf16_f32 v24, v24, v25
    v_mfma_f32_16x16x16_bf16 v[36:39], v[208:209], v[10:11], 0
    v_cvt_pk_bf16_f32 v25, v26, v27
    v_pk_max_i16 v24, v24, 0
    v_pk_max_i16 v25, v25, 0
    v_cvt_pk_bf16_f32 v28, v28, v29
    v_cvt_pk_bf16_f32 v29, v30, v31
    v_mfma_f32_16x16x16_bf16 v[40:43], v[210:211], v[24:25], 0
    v_pk_max_i16 v28, v28, 0
    v_pk_max_i16 v29, v29, 0
    v_cvt_pk_bf16_f32 v32, v32, v33
    v_cvt_pk_bf16_f32 v33, v34, v35
    v_mfma_f32_16x16x16_bf16 v[40:43], v[212:213], v[28:29], v[40:43]
    v_pk_max_i16 v32, v32, 0
    v_pk_max_i16 v33, v33, 0
    v_cvt_pk_bf16_f32 v36, v36, v37
    v_cvt_pk_bf16_f32 v37, v38, v39
    v_mfma_f32_16x16x16_bf16 v[40:43], v[214:215], v[32:33], v[40:43]
    v_pk_max_i16 v36, v36, 0
    v_pk_max_i16 v37, v37, 0
    v_mov_b32 v11, 0x41b8aa3b
    v_min_u32 v10, 175, v0
    v_mfma_f32_16x16x16_bf16 v[40:43], v[216:217], v[36:37], v[40:43]
    v_lshlrev_b32 v10, 2, v10
    s_nop 6
    v_cvt_pk_bf16_f32 v40, v40, v40
    v_cvt_pk_bf16_f32 v41, v41, v41
    v_cvt_pk_bf16_f32 v42, v42, v42
    v_cvt_pk_bf16_f32 v43, v43, v43
    v_lshlrev_b32 v40, 16, v40
    v_lshlrev_b32 v41, 16, v41
    v_lshlrev_b32 v42, 16, v42
    v_lshlrev_b32 v43, 16, v43
    v_mul_f32 v40, 0xbfb8aa3b, v40
    v_mul_f32 v41, 0xbfb8aa3b, v41
    v_mul_f32 v42, 0xbfb8aa3b, v42
    v_mul_f32 v43, 0xbfb8aa3b, v43
    v_exp_f32 v40, v40
    v_exp_f32 v41, v41
    v_exp_f32 v42, v42
    v_exp_f32 v43, v43
    v_add_f32 v40, 1.0, v40
    v_add_f32 v41, 1.0, v41
    v_add_f32 v42, 1.0, v42
    v_add_f32 v43, 1.0, v43
    v_rcp_f32 v40, v40
    v_rcp_f32 v41, v41
    v_rcp_f32 v42, v42
    v_rcp_f32 v43, v43
    v_cvt_pk_bf16_f32 v40, v40, v40
    v_cvt_pk_bf16_f32 v41, v41, v41
    v_cvt_pk_bf16_f32 v42, v42, v42
    v_cvt_pk_bf16_f32 v43, v43, v43
    v_lshlrev_b32 v40, 16, v40
    v_lshlrev_b32 v41, 16, v41
    v_lshlrev_b32 v42, 16, v42
    v_lshlrev_b32 v43, 16, v43
    v_fma_f32 v40, v40, v11, v12
    v_fma_f32 v41, v41, v11, v12
    v_fma_f32 v42, v42, v11, v12
    v_fma_f32 v43, v43, v11, v12
    ds_write_b32 v10, v40 offset:56320
    ds_write_b32 v10, v41 offset:57024
    ds_write_b32 v10, v42 offset:57728
    ds_write_b32 v10, v43 offset:58432
    s_waitcnt lgkmcnt(0)
    s_branch L_skiptab
L_dum:
    v_add_u32 v2, 148224, v163
    ds_write_b128 v2, v[218:221]
    ds_write_b128 v2, v[218:221] offset:896
    v_mov_b32 v2, 154240
    ds_write_b128 v2, v[218:221]
    s_waitcnt lgkmcnt(0)
L_skiptab:
    s_waitcnt vmcnt(6)
    s_barrier
    ds_read_b128 v[190:193], v176
    ds_read_b128 v[194:197], v176 offset:2304
    ds_read_b128 v[198:201], v176 offset:18560
    ds_read_b128 v[234:237], v176 offset:20864
    ds_read_b128 v[238:241], v176 offset:37120
    ds_read_b128 v[242:245], v176 offset:39424
    ds_read_b64_tr_b16 v[0:1], v175
    ds_read_b64_tr_b16 v[12:13], v175 offset:192
    ds_read_b64_tr_b16 v[36:37], v175 offset:384
    ds_read_b64_tr_b16 v[2:3], v175 offset:2304
    ds_read_b64_tr_b16 v[14:15], v175 offset:2496
    ds_read_b64_tr_b16 v[38:39], v175 offset:2688
    ds_read_b64_tr_b16 v[4:5], v175 offset:18560
    ds_read_b64_tr_b16 v[16:17], v175 offset:18752
    ds_read_b64_tr_b16 v[40:41], v175 offset:18944
    ds_read_b64_tr_b16 v[6:7], v175 offset:20864
    ds_read_b64_tr_b16 v[18:19], v175 offset:21056
    ds_read_b64_tr_b16 v[42:43], v175 offset:21248
    ds_read_b64_tr_b16 v[8:9], v175 offset:37120
    ds_read_b64_tr_b16 v[20:21], v175 offset:37312
    ds_read_b64_tr_b16 v[44:45], v175 offset:37504
    ds_read_b64_tr_b16 v[10:11], v175 offset:39424
    ds_read_b64_tr_b16 v[22:23], v175 offset:39616
    ds_read_b64_tr_b16 v[46:47], v175 offset:39808
    s_lshl_b32 s22, s16, 4
    s_lshr_b64 s[70:71], s[70:71], s22
    s_lshl_b32 s22, s70, 16
    v_mov_b32 v202, s22
    v_min_f32 v202, 0x40930000, v202
    v_max_f32 v202, 0xc2c80000, v202
    v_mul_f32 v202, 0x3fb8aa3b, v202
    v_exp_f32 v202, v202
    s_nop 0
    v_cvt_pk_bf16_f32 v202, v202, v202
    v_lshlrev_b32 v202, 16, v202
    s_nop 0
    v_readfirstlane_b32 s30, v202
    v_mul_f32 v202, 0x3fb8aa3b, v202
    s_nop 0
    v_readfirstlane_b32 s31, v202
    s_cmp_gt_u32 s30, 0x419c0000
    s_cselect_b32 s30, 1, 0
    v_mov_b32 v174, 0x3f803f80
    v_mov_b32 v175, 0x3f803f80
    v_mov_b32 v176, 0x3f803f80
    v_mov_b32 v177, 0x3f803f80
    s_or_b32 s23, s34, s35
    s_waitcnt lgkmcnt(0)
    s_cbranch_scc1 L_pads0
L_pads0r:
    s_waitcnt vmcnt(3)
    v_mfma_f32_16x16x32_bf16 v[218:221], v[222:225], v[174:177], 0
    v_mfma_f32_16x16x32_bf16 v[218:221], v[226:229], v[174:177], v[218:221]
    v_mfma_f32_16x16x32_bf16 v[218:221], v[230:233], v[174:177], v[218:221]
    v_mfma_f32_16x16x32_bf16 v[214:217], v[194:197], v[170:173], 0
    s_nop 6
    v_mul_f32 v218, 0xbc2aaaab, v218
    v_mul_f32 v219, 0xbc2aaaab, v219
    v_mul_f32 v220, 0xbc2aaaab, v220
    v_mul_f32 v221, 0xbc2aaaab, v221
    v_cvt_pk_bf16_f32 v50, v214, v215
    v_cvt_pk_bf16_f32 v51, v216, v217
    v_mfma_f32_16x16x32_bf16 v[202:205], v[222:225], v[248:251], v[218:221]
    v_mfma_f32_16x16x32_bf16 v[206:209], v[222:225], v[246:249], v[218:221]
    v_mfma_f32_16x16x32_bf16 v[210:213], v[226:229], v[248:251], v[218:221]
    s_nop 5
    v_cvt_pk_bf16_f32 v114, v202, v203
    v_cvt_pk_bf16_f32 v115, v204, v205
    v_mfma_f32_16x16x32_bf16 v[202:205], v[226:229], v[246:249], v[218:221]
    v_cvt_pk_bf16_f32 v118, v206, v207
    v_cvt_pk_bf16_f32 v119, v208, v209
    v_mfma_f32_16x16x32_bf16 v[206:209], v[230:233], v[248:251], v[218:221]
    v_cvt_pk_bf16_f32 v122, v210, v211
    v_cvt_pk_bf16_f32 v123, v212, v213
    v_mfma_f32_16x16x32_bf16 v[210:213], v[230:233], v[246:249], v[218:221]
    ds_write_b64 v252, v[114:115]
    s_nop 0
    v_cvt_pk_bf16_f32 v130, v202, v203
    v_cvt_pk_bf16_f32 v131, v204, v205
    v_mfma_f32_16x16x32_bf16 v[202:205], v[190:193], v[146:149], 0
    v_cvt_pk_bf16_f32 v134, v206, v207
    v_cvt_pk_bf16_f32 v135, v208, v209
    v_mfma_f32_16x16x32_bf16 v[206:209], v[190:193], v[170:173], 0
    v_cvt_pk_bf16_f32 v138, v210, v211
    v_cvt_pk_bf16_f32 v139, v212, v213
    v_mfma_f32_16x16x32_bf16 v[210:213], v[194:197], v[146:149], 0
    ds_write_b64 v252, v[118:119] offset:3072
    s_nop 0
    v_cvt_pk_bf16_f32 v24, v202, v203
    v_cvt_pk_bf16_f32 v25, v204, v205
    v_mfma_f32_16x16x32_bf16 v[202:205], v[198:201], v[146:149], 0
    v_cvt_pk_bf16_f32 v48, v206, v207
    v_cvt_pk_bf16_f32 v49, v208, v209
    v_mfma_f32_16x16x32_bf16 v[206:209], v[198:201], v[170:173], 0
    v_cvt_pk_bf16_f32 v26, v210, v211
    v_cvt_pk_bf16_f32 v27, v212, v213
    v_mfma_f32_16x16x32_bf16 v[210:213], v[234:237], v[146:149], 0
    ds_write_b64 v252, v[122:123] offset:6144
    s_nop 0
    v_cvt_pk_bf16_f32 v28, v202, v203
    v_mfma_f32_16x16x32_bf16 v[214:217], v[234:237], v[170:173], 0
    v_cvt_pk_bf16_f32 v29, v204, v205
    v_cvt_pk_bf16_f32 v52, v206, v207
    v_cvt_pk_bf16_f32 v53, v208, v209
    v_mfma_f32_16x16x32_bf16 v[202:205], v[238:241], v[146:149], 0
    v_cvt_pk_bf16_f32 v30, v210, v211
    v_cvt_pk_bf16_f32 v31, v212, v213
    v_mfma_f32_16x16x32_bf16 v[206:209], v[238:241], v[170:173], 0
    s_nop 0
    v_cvt_pk_bf16_f32 v54, v214, v215
    v_cvt_pk_bf16_f32 v55, v216, v217
    v_mfma_f32_16x16x32_bf16 v[210:213], v[242:245], v[146:149], 0
    ds_write_b64 v252, v[130:131] offset:9216
    v_cvt_pk_bf16_f32 v32, v202, v203
    v_mfma_f32_16x16x32_bf16 v[214:217], v[242:245], v[170:173], 0
    ds_write_b64 v252, v[134:135] offset:12288
    v_cvt_pk_bf16_f32 v33, v204, v205
    ds_write_b64 v252, v[138:139] offset:15360
    v_cvt_pk_bf16_f32 v56, v206, v207
    v_mov_b32 v166, 154240
    v_mov_b32 v167, 1
    s_mov_b64 exec, 1
    ds_add_u32 v166, v167 offset:4
    ds_add_u32 v166, v167 offset:12
    s_mov_b64 exec, -1
    v_cvt_pk_bf16_f32 v57, v208, v209
    v_cvt_pk_bf16_f32 v34, v210, v211
    v_cvt_pk_bf16_f32 v35, v212, v213
    v_cvt_pk_bf16_f32 v58, v214, v215
    v_cvt_pk_bf16_f32 v59, v216, v217
    s_add_u32 s40, s16, s19
    s_add_u32 s40, s40, 3
    s_and_b32 s40, s40, 3
    v_subrev_u32 v111, 59136, v110
    s_add_u32 s20, s20, 1344
    v_lshrrev_b32 v111, 2, v111
    s_lshl_b64 s[42:43], s[28:29], s19
    s_ashr_i32 s33, s32, 1
    s_add_u32 s33, s33, 3072
    s_mul_i32 s22, s40, 3072
    s_add_u32 s22, s22, s32
    s_sub_u32 s22, s22, s37
    v_add_u32 v109, s22, v99
    s_lshl_b32 s23, s40, 8
    s_cmp_eq_u32 s40, 3
    s_cselect_b32 s23, 0, s23
    s_cselect_b32 s38, 3, 6
    s_add_u32 s23, s23, s76
    s_cmp_eq_u32 s19, s38
    s_cselect_b32 s38, 1024, 0
    s_cselect_b32 s22, 0, s20
    s_add_u32 s23, s23, s38
    v_add_u32 v111, s23, v111
    s_mov_b32 m0, s79
    s_add_u32 s23, s36, 9216
    s_sub_u32 s38, s22, 1344
    s_cmp_eq_u32 s16, 0
    s_cselect_b32 m0, s23, m0
    s_cselect_b32 s22, s38, s22
    s_cmp_gt_u32 s16, 1
    s_cselect_b32 m0, 0x30000, m0
    s_cselect_b32 s22, 0x40000000, s22
    s_add_u32 s38, s22, 64
    s_add_u32 s39, s22, 128
    s_waitcnt vmcnt(0)
    s_waitcnt lgkmcnt(0)
    s_barrier
    s_cmp_lg_u32 s30, 0
    s_cbranch_scc1 L_slow0
    s_setprio 1
    ds_read_b128 v[178:181], v253
    ds_read_b128 v[190:193], v97
    ds_read_b128 v[182:185], v253 offset:1024
    ds_read_b128 v[194:197], v97 offset:1024
    ds_read_b128 v[186:189], v253 offset:2048
    ds_read_b128 v[198:201], v97 offset:2048
    ds_read_b32 v102, v102
    ds_read_b32 v104, v104
    ds_read_b32 v106, v106
    ds_read_b32 v108, v108 offset:336
    ds_read_b32 v162, v111
    s_waitcnt lgkmcnt(10)
    v_mfma_f32_16x16x32_bf16 v[222:225], v[0:3], v[178:181], 0
    ds_read2_b32 v[60:61], v60 offset0:84 offset1:83
    ds_read_b32 v62, v62 offset:328
    v_mfma_f32_16x16x32_bf16 v[226:229], v[12:15], v[178:181], 0
    ds_read_b32 v63, v63 offset:324
    ds_read_b32 v64, v64 offset:272
    s_waitcnt lgkmcnt(13)
    v_mfma_f32_16x16x32_bf16 v[202:205], v[0:3], v[190:193], 0
    ds_read_b32 v65, v65 offset:268
    ds_read2_b32 v[66:67], v66 offset0:66 offset1:65
    v_mfma_f32_16x16x32_bf16 v[206:209], v[12:15], v[190:193], 0
    ds_read_b32 v163, v111 offset:256
    ds_read_b32 v96, v96
    v_mfma_f32_16x16x32_bf16 v[230:233], v[24:27], v[178:181], 0
    ds_read_b32 v98, v98
    ds_read2_b32 v[68:69], v68 offset0:52 offset1:51
    s_waitcnt lgkmcnt(15)
    v_mfma_f32_16x16x32_bf16 v[222:225], v[4:7], v[182:185], v[222:225]
    ds_read_b32 v70, v70 offset:200
    ds_read_b32 v71, v71 offset:196
    v_mfma_f32_16x16x32_bf16 v[226:229], v[16:19], v[182:185], v[226:229]
    ds_read_b32 v164, v111 offset:512
    ds_read2_b32 v[72:73], v72 offset0:84 offset1:83
    v_mfma_f32_16x16x32_bf16 v[210:213], v[24:27], v[190:193], 0
    ds_read_b32 v74, v74 offset:328
    s_waitcnt lgkmcnt(15)
    buffer_load_dwordx4 v162, s[4:7], s22 offen lds
    s_add_u32 m0, m0, 1024
    v_mfma_f32_16x16x32_bf16 v[202:205], v[4:7], v[194:197], v[202:205]
    ds_read_b32 v75, v75 offset:324
    ds_read_b32 v76, v76 offset:272
    v_mfma_f32_16x16x32_bf16 v[206:209], v[16:19], v[194:197], v[206:209]
    ds_read_b32 v77, v77 offset:268
    ds_read2_b32 v[78:79], v78 offset0:66 offset1:65
    v_mfma_f32_16x16x32_bf16 v[230:233], v[28:31], v[182:185], v[230:233]
    ds_read2_b32 v[84:85], v84 offset0:84 offset1:83
    ds_read_b32 v86, v86 offset:328
    v_mfma_f32_16x16x32_bf16 v[222:225], v[8:11], v[186:189], v[222:225]
    ds_read_b32 v87, v87 offset:324
    ds_read_b32 v88, v88 offset:272
    v_mfma_f32_16x16x32_bf16 v[226:229], v[20:23], v[186:189], v[226:229]
    ds_read_b32 v89, v89 offset:268
    buffer_load_dwordx4 v162, s[4:7], s38 offen lds
    s_add_u32 m0, m0, 1024
    v_mfma_f32_16x16x32_bf16 v[210:213], v[28:31], v[194:197], v[210:213]
    s_nop 0
    v_fma_f32 v250, v222, v222, s24
    v_fma_f32 v251, v223, v223, s24
    v_mfma_f32_16x16x32_bf16 v[202:205], v[8:11], v[198:201], v[202:205]
    v_fma_f32 v252, v226, v226, s24
    v_fma_f32 v253, v227, v227, s24
    v_mfma_f32_16x16x32_bf16 v[206:209], v[20:23], v[198:201], v[206:209]
    v_fmac_f32 v252, v228, v228
    v_fmac_f32 v253, v229, v229
    v_mfma_f32_16x16x32_bf16 v[230:233], v[32:35], v[186:189], v[230:233]
    v_fmac_f32 v250, v224, v224
    v_fmac_f32 v251, v225, v225
    v_mfma_f32_16x16x32_bf16 v[210:213], v[32:35], v[198:201], v[210:213]
    v_fma_f32 v246, v202, v202, s24
    s_nop 0
    v_fma_f32 v248, v206, v206, s24
    v_mfma_f32_16x16x32_bf16 v[214:217], v[190:193], v[36:39], 0
    v_fma_f32 v249, v207, v207, s24
    v_fma_f32 v247, v203, v203, s24
    v_mfma_f32_16x16x32_bf16 v[218:221], v[190:193], v[48:51], 0
    ds_read_b128 v[190:193], v97 offset:3072
    v_fmac_f32 v252, v232, v232
    v_mfma_f32_16x16x32_bf16 v[234:237], v[178:181], v[36:39], 0
    v_fmac_f32 v253, v233, v233
    v_fmac_f32 v250, v230, v230
    v_mfma_f32_16x16x32_bf16 v[238:241], v[178:181], v[48:51], 0
    ds_read_b128 v[178:181], v97 offset:6144
    v_fmac_f32 v251, v231, v231
    v_mfma_f32_16x16x32_bf16 v[214:217], v[194:197], v[40:43], v[214:217]
    v_fmac_f32 v248, v208, v208
    v_fmac_f32 v249, v209, v209
    v_mfma_f32_16x16x32_bf16 v[218:221], v[194:197], v[52:55], v[218:221]
    ds_read_b128 v[194:197], v97 offset:4096
    v_fmac_f32 v246, v204, v204
    v_mfma_f32_16x16x32_bf16 v[234:237], v[182:185], v[40:43], v[234:237]
    v_fmac_f32 v247, v205, v205
    v_cvt_pk_bf16_f32 v244, v250, v251
    v_mfma_f32_16x16x32_bf16 v[238:241], v[182:185], v[52:55], v[238:241]
    ds_read_b128 v[182:185], v97 offset:7168
    v_cvt_pk_bf16_f32 v245, v252, v253
    v_mfma_f32_16x16x32_bf16 v[214:217], v[198:201], v[44:47], v[214:217]
    v_fmac_f32 v248, v212, v212
    v_fmac_f32 v249, v213, v213
    v_mfma_f32_16x16x32_bf16 v[218:221], v[198:201], v[56:59], v[218:221]
    v_fmac_f32 v246, v210, v210
    v_fmac_f32 v247, v211, v211
    v_mfma_f32_16x16x32_bf16 v[234:237], v[186:189], v[44:47], v[234:237]
    ds_read_b128 v[198:201], v97 offset:5120
    v_cvt_pk_bf16_f32 v254, v246, v247
    v_mfma_f32_16x16x32_bf16 v[238:241], v[186:189], v[56:59], v[238:241]
    v_cvt_pk_bf16_f32 v255, v248, v249
    ds_read_b128 v[186:189], v97 offset:8192
    v_mfma_f32_16x16x16_bf16 v[250:253], v[112:113], v[244:245], 0
    v_cvt_pk_bf16_f32 v146, v214, v215
    s_nop 0
    v_cvt_pk_bf16_f32 v234, v234, v235
    v_mfma_f32_16x16x16_bf16 v[246:249], v[112:113], v[254:255], 0
    v_cvt_pk_bf16_f32 v235, v236, v237
    v_cvt_pk_bf16_f32 v238, v238, v239
    v_cvt_pk_bf16_f32 v239, v240, v241
    v_or_b32 v238, v238, v154
    v_or_b32 v239, v239, v154
    v_rsq_f32 v250, v250
    v_rsq_f32 v252, v252
    s_nop 0
    v_rsq_f32 v246, v246
    v_mul_f32 v250, s31, v250
    v_rsq_f32 v248, v248
    v_mul_f32 v226, v252, v226
    v_mul_f32 v227, v252, v227
    v_mul_f32 v228, v252, v228
    v_mul_f32 v229, v252, v229
    v_mul_f32 v222, v250, v222
    v_mul_f32 v223, v250, v223
    v_mul_f32 v224, v250, v224
    v_mul_f32 v225, v250, v225
    v_mul_f32 v246, s31, v246
    v_cvt_pk_bf16_f32 v142, v226, v227
    v_cvt_pk_bf16_f32 v143, v228, v229
    v_cvt_pk_bf16_f32 v126, v222, v223
    v_cvt_pk_bf16_f32 v127, v224, v225
    v_mul_f32 v206, v248, v206
    v_mul_f32 v207, v248, v207
    v_mul_f32 v208, v248, v208
    v_mul_f32 v209, v248, v209
    v_mul_f32 v202, v246, v202
    v_mul_f32 v203, v246, v203
    v_mul_f32 v204, v246, v204
    v_mul_f32 v205, v246, v205
    s_mov_b32 exec_lo, 0xffffffff
    s_mov_b32 exec_hi, 0x0
    ds_write_b16 v168, v234 offset:256
    ds_write_b16_d16_hi v168, v234 offset:576
    ds_write_b16 v168, v238 offset:264
    ds_write_b16_d16_hi v168, v238 offset:584
    s_mov_b32 exec_lo, 0xffff
    s_mov_b32 exec_hi, 0x0
    ds_write_b16 v168, v235 offset:896
    ds_write_b16_d16_hi v168, v235 offset:1216
    ds_write_b16 v168, v239 offset:904
    ds_write_b16_d16_hi v168, v239 offset:1224
    s_mov_b64 exec, -1
    s_waitcnt lgkmcnt(13)
    v_mfma_f32_16x16x32_bf16 v[222:225], v[0:3], v[190:193], 0
    v_mul_f32 v232, v252, v232
    v_mul_f32 v233, v252, v233
    v_mfma_f32_16x16x32_bf16 v[226:229], v[12:15], v[190:193], 0
    v_mul_f32 v230, v250, v230
    v_mul_f32 v231, v250, v231
    v_cvt_pk_bf16_f32 v130, v206, v207
    v_cvt_pk_bf16_f32 v131, v208, v209
    v_cvt_pk_bf16_f32 v114, v202, v203
    v_cvt_pk_bf16_f32 v115, v204, v205
    s_waitcnt lgkmcnt(12)
    v_mfma_f32_16x16x32_bf16 v[202:205], v[0:3], v[178:181], 0
    v_cvt_pk_bf16_f32 v144, v232, v233
    v_cvt_pk_bf16_f32 v128, v230, v231
    v_mfma_f32_16x16x32_bf16 v[206:209], v[12:15], v[178:181], 0
    v_mul_f32 v212, v248, v212
    v_mul_f32 v213, v248, v213
    v_mul_f32 v210, v246, v210
    v_mul_f32 v211, v246, v211
    v_mfma_f32_16x16x32_bf16 v[230:233], v[24:27], v[190:193], 0
    v_cvt_pk_bf16_f32 v132, v212, v213
    v_cvt_pk_bf16_f32 v116, v210, v211
    s_waitcnt lgkmcnt(11)
    v_mfma_f32_16x16x32_bf16 v[222:225], v[4:7], v[194:197], v[222:225]
    s_mov_b32 exec_lo, 0x3f003f
    s_mov_b32 exec_hi, 0x3f003f
    ds_write_b128 v165, v[126:129]
    ds_write_b128 v165, v[142:145] offset:64
    s_mov_b64 exec, -1
    v_mfma_f32_16x16x32_bf16 v[226:229], v[16:19], v[194:197], v[226:229]
    s_mov_b64 exec, s[26:27]
    v_cvt_pk_bf16_f32 v154, v218, v219
    v_cvt_pk_bf16_f32 v155, v220, v221
    s_mov_b64 exec, -1
    v_mfma_f32_16x16x32_bf16 v[210:213], v[24:27], v[178:181], 0
    ds_read_b128 v[126:129], v103
    v_cvt_pk_bf16_f32 v147, v216, v217
    s_waitcnt lgkmcnt(13)
    v_mfma_f32_16x16x32_bf16 v[202:205], v[4:7], v[182:185], v[202:205]
    ds_read_b128 v[142:145], v103 offset:64
    buffer_load_dwordx4 v162, s[4:7], s39 offen lds
    s_add_u32 m0, m0, 1024
    v_mfma_f32_16x16x32_bf16 v[206:209], v[16:19], v[182:185], v[206:209]
    ds_read_u16 v160, v105 offset:264
    ds_read_u16 v152, v105 offset:256
    v_mfma_f32_16x16x32_bf16 v[230:233], v[28:31], v[194:197], v[230:233]
    ds_read2_b32 v[90:91], v90 offset0:66 offset1:65
    ds_read_b32 v100, v100
    s_waitcnt lgkmcnt(15)
    v_mfma_f32_16x16x32_bf16 v[222:225], v[8:11], v[198:201], v[222:225]
    ds_read2_b32 v[80:81], v80 offset0:52 offset1:51
    ds_read_b32 v82, v82 offset:200
    v_mfma_f32_16x16x32_bf16 v[226:229], v[20:23], v[198:201], v[226:229]
    ds_read_b32 v83, v83 offset:196
    ds_read2_b32 v[92:93], v92 offset0:52 offset1:51
    v_mfma_f32_16x16x32_bf16 v[210:213], v[28:31], v[182:185], v[210:213]
    ds_read_b32 v94, v94 offset:200
    s_nop 0
    v_fma_f32 v250, v222, v222, s24
    v_mfma_f32_16x16x32_bf16 v[202:205], v[8:11], v[186:189], v[202:205]
    v_fma_f32 v251, v223, v223, s24
    v_fma_f32 v252, v226, v226, s24
    v_mfma_f32_16x16x32_bf16 v[206:209], v[20:23], v[186:189], v[206:209]
    v_fma_f32 v253, v227, v227, s24
    v_fmac_f32 v252, v228, v228
    v_mfma_f32_16x16x32_bf16 v[230:233], v[32:35], v[198:201], v[230:233]
    v_fmac_f32 v253, v229, v229
    v_fmac_f32 v250, v224, v224
    v_mfma_f32_16x16x32_bf16 v[210:213], v[32:35], v[186:189], v[210:213]
    v_fmac_f32 v251, v225, v225
    s_nop 0
    v_fma_f32 v248, v206, v206, s24
    v_fma_f32 v249, v207, v207, s24
    v_fma_f32 v246, v202, v202, s24
    v_fma_f32 v247, v203, v203, s24
    v_fmac_f32 v252, v232, v232
    v_fmac_f32 v253, v233, v233
    v_fmac_f32 v250, v230, v230
    v_fmac_f32 v251, v231, v231
    v_fmac_f32 v248, v208, v208
    v_fmac_f32 v249, v209, v209
    v_fmac_f32 v246, v204, v204
    v_fmac_f32 v247, v205, v205
    v_cvt_pk_bf16_f32 v244, v250, v251
    v_cvt_pk_bf16_f32 v245, v252, v253
    v_fmac_f32 v248, v212, v212
    v_fmac_f32 v249, v213, v213
    v_fmac_f32 v246, v210, v210
    v_fmac_f32 v247, v211, v211
    v_cvt_pk_bf16_f32 v255, v248, v249
    v_cvt_pk_bf16_f32 v254, v246, v247
    v_mfma_f32_16x16x16_bf16 v[250:253], v[112:113], v[244:245], 0
    ds_read_b32 v95, v95 offset:196
    buffer_load_dwordx4 v163, s[4:7], s22 offen lds
    s_add_u32 m0, m0, 1024
    v_mfma_f32_16x16x16_bf16 v[246:249], v[112:113], v[254:255], 0
    v_mfma_f32_16x16x32_bf16 v[214:217], v[178:181], v[36:39], 0
    s_nop 2
    v_rsq_f32 v252, v252
    v_mfma_f32_16x16x32_bf16 v[218:221], v[178:181], v[48:51], 0
    v_mul_f32 v226, v252, v226
    s_nop 0
    v_rsq_f32 v248, v248
    v_mul_f32 v227, v252, v227
    v_mul_f32 v228, v252, v228
    v_mul_f32 v229, v252, v229
    v_mul_f32 v232, v252, v232
    v_mul_f32 v233, v252, v233
    v_mfma_f32_16x16x32_bf16 v[214:217], v[182:185], v[40:43], v[214:217]
    v_cvt_pk_bf16_f32 v134, v226, v227
    v_cvt_pk_bf16_f32 v135, v228, v229
    v_mfma_f32_16x16x32_bf16 v[218:221], v[182:185], v[52:55], v[218:221]
    v_cvt_pk_bf16_f32 v136, v232, v233
    v_mul_f32 v206, v248, v206
    v_mul_f32 v207, v248, v207
    v_mul_f32 v208, v248, v208
    v_mul_f32 v209, v248, v209
    v_mul_f32 v212, v248, v212
    v_mul_f32 v213, v248, v213
    v_cvt_pk_bf16_f32 v138, v206, v207
    v_cvt_pk_bf16_f32 v139, v208, v209
    v_cvt_pk_bf16_f32 v140, v212, v213
    v_mfma_f32_16x16x32_bf16 v[234:237], v[190:193], v[36:39], 0
    v_rsq_f32 v250, v250
    v_mfma_f32_16x16x32_bf16 v[238:241], v[190:193], v[48:51], 0
    v_mul_f32 v250, s31, v250
    buffer_load_dwordx4 v163, s[4:7], s38 offen lds
    s_add_u32 m0, m0, 1024
    v_mfma_f32_16x16x32_bf16 v[214:217], v[186:189], v[44:47], v[214:217]
    v_mul_f32 v222, v250, v222
    v_mul_f32 v223, v250, v223
    v_mfma_f32_16x16x32_bf16 v[218:221], v[186:189], v[56:59], v[218:221]
    v_mul_f32 v224, v250, v224
    v_mul_f32 v225, v250, v225
    s_waitcnt lgkmcnt(11)
    v_mfma_f32_16x16x32_bf16 v[178:181], v[126:129], v[130:133], v[102:105]
    v_cvt_pk_bf16_f32 v118, v222, v223
    v_cvt_pk_bf16_f32 v119, v224, v225
    v_mfma_f32_16x16x32_bf16 v[182:185], v[126:129], v[134:137], v[104:107]
    v_mul_f32 v230, v250, v230
    v_mul_f32 v231, v250, v231
    s_waitcnt lgkmcnt(10)
    v_mfma_f32_16x16x32_bf16 v[190:193], v[126:129], v[142:145], v[108:111]
    v_cvt_pk_bf16_f32 v120, v230, v231
    v_exp_f32 v178, v178
    v_mfma_f32_16x16x32_bf16 v[186:189], v[126:129], v[138:141], v[106:109]
    s_nop 0
    v_exp_f32 v182, v182
    v_mfma_f32_16x16x32_bf16 v[234:237], v[194:197], v[40:43], v[234:237]
    s_nop 1
    v_exp_f32 v190, v190
    v_cvt_pk_bf16_f32 v179, v178, v182
    v_mfma_f32_16x16x32_bf16 v[238:241], v[194:197], v[52:55], v[238:241]
    v_exp_f32 v186, v186
    ds_write_b16 v105, v179 offset:128
    v_mfma_f32_16x16x32_bf16 v[234:237], v[198:201], v[44:47], v[234:237]
    v_cvt_pk_bf16_f32 v183, v186, v190
    ds_write_b16_d16_hi v105, v179 offset:136
    v_mfma_f32_16x16x32_bf16 v[238:241], v[198:201], v[56:59], v[238:241]
    ds_write_b16 v105, v183 offset:192
    buffer_load_dwordx4 v163, s[4:7], s39 offen lds
    s_add_u32 m0, m0, 1024
    ds_write_b16_d16_hi v105, v183 offset:200
    v_mfma_f32_16x16x32_bf16 v[222:225], v[130:133], v[114:117], v[60:63]
    ds_read_b128 v[170:173], v103 offset:128
    v_cvt_pk_bf16_f32 v148, v234, v235
    v_mfma_f32_16x16x32_bf16 v[226:229], v[134:137], v[114:117], v[64:67]
    ds_read_b128 v[174:177], v103 offset:192
    v_cvt_pk_bf16_f32 v149, v236, v237
    v_mfma_f32_16x16x32_bf16 v[234:237], v[142:145], v[114:117], v[96:99]
    s_mov_b64 exec, s[26:27]
    v_cvt_pk_bf16_f32 v156, v238, v239
    v_cvt_pk_bf16_f32 v157, v240, v241
    s_mov_b64 exec, -1
    v_mfma_f32_16x16x32_bf16 v[230:233], v[138:141], v[114:117], v[68:71]
    s_mov_b64 exec, s[26:27]
    v_cvt_pk_bf16_f32 v158, v218, v219
    v_cvt_pk_bf16_f32 v159, v220, v221
    s_mov_b64 exec, -1
    buffer_load_dwordx4 v164, s[4:7], s22 offen lds
    s_add_u32 m0, m0, 1024
    v_exp_f32 v222, v222
    v_exp_f32 v223, v223
    v_exp_f32 v224, v224
    v_exp_f32 v225, v225
    v_exp_f32 v226, v226
    s_setprio 0
    v_exp_f32 v227, v227
    v_exp_f32 v228, v228
    v_exp_f32 v229, v229
    v_rsq_f32 v246, v246
    buffer_load_dwordx4 v164, s[4:7], s38 offen lds
    s_add_u32 m0, m0, 1024
    s_waitcnt lgkmcnt(1)
    v_mfma_f32_16x16x32_bf16 v[242:245], v[154:157], v[170:173], 0
    v_exp_f32 v234, v234
    v_cvt_pk_bf16_f32 v162, v222, v223
    v_cvt_pk_bf16_f32 v163, v224, v225
    v_cvt_pk_bf16_f32 v165, v228, v229
    v_exp_f32 v230, v230
    v_exp_f32 v231, v231
    v_exp_f32 v232, v232
    v_exp_f32 v233, v233
    v_mul_f32 v246, s31, v246
    v_mfma_f32_16x16x32_bf16 v[238:241], v[146:149], v[170:173], 0
    buffer_load_dwordx4 v164, s[4:7], s39 offen lds
    s_add_u32 m0, m0, 1024
    v_cvt_pk_bf16_f32 v164, v226, v227
    s_waitcnt lgkmcnt(0)
    v_mfma_f32_16x16x32_bf16 v[242:245], v[158:161], v[174:177], v[242:245]
    v_cvt_pk_bf16_f32 v150, v214, v215
    v_cvt_pk_bf16_f32 v151, v216, v217
    v_mfma_f32_16x16x32_bf16 v[198:201], v[154:157], v[162:165], 0
    v_mul_f32 v202, v246, v202
    v_mul_f32 v203, v246, v203
    v_mul_f32 v204, v246, v204
    v_mul_f32 v205, v246, v205
    v_mul_f32 v210, v246, v210
    v_mul_f32 v211, v246, v211
    v_cvt_pk_bf16_f32 v168, v234, 0
    v_cvt_pk_bf16_f32 v166, v230, v231
    v_cvt_pk_bf16_f32 v167, v232, v233
    v_cvt_pk_bf16_f32 v122, v202, v203
    v_cvt_pk_bf16_f32 v123, v204, v205
    v_cvt_pk_bf16_f32 v124, v210, v211
    v_mfma_f32_16x16x32_bf16 v[238:241], v[150:153], v[174:177], v[238:241]
    v_rcp_f32 v244, v244
    v_mfma_f32_16x16x32_bf16 v[198:201], v[158:161], v[166:169], v[198:201]
    v_mul_f32 v242, v244, v242
    v_mul_f32 v243, v244, v243
    v_mfma_f32_16x16x32_bf16 v[178:181], v[130:133], v[118:121], v[72:75]
    v_cvt_pk_bf16_f32 v242, v242, v243
    s_nop 1
    v_mul_f32 v238, v244, v238
    v_mfma_f32_16x16x32_bf16 v[182:185], v[134:137], v[118:121], v[76:79]
    v_mul_f32 v239, v244, v239
    v_rcp_f32 v200, v200
    v_mfma_f32_16x16x32_bf16 v[222:225], v[130:133], v[122:125], v[84:87]
    v_mul_f32 v240, v244, v240
    v_mul_f32 v241, v244, v241
    v_mfma_f32_16x16x32_bf16 v[226:229], v[134:137], v[122:125], v[88:91]
    v_cvt_pk_bf16_f32 v238, v238, v239
    v_cvt_pk_bf16_f32 v239, v240, v241
    v_mfma_f32_16x16x32_bf16 v[194:197], v[146:149], v[162:165], 0
    v_exp_f32 v178, v178
    v_mfma_f32_16x16x32_bf16 v[190:193], v[142:145], v[118:121], v[98:101]
    v_exp_f32 v179, v179
    v_mfma_f32_16x16x32_bf16 v[186:189], v[138:141], v[118:121], v[80:83]
    v_exp_f32 v180, v180
    v_mfma_f32_16x16x32_bf16 v[234:237], v[142:145], v[122:125], v[100:103]
    v_exp_f32 v181, v181
    v_mfma_f32_16x16x32_bf16 v[230:233], v[138:141], v[122:125], v[92:95]
    v_exp_f32 v182, v182
    v_mfma_f32_16x16x32_bf16 v[194:197], v[150:153], v[166:169], v[194:197]
    v_exp_f32 v183, v183
    v_exp_f32 v184, v184
    v_exp_f32 v185, v185
    v_exp_f32 v222, v222
    v_exp_f32 v223, v223
    v_exp_f32 v224, v224
    v_exp_f32 v225, v225
    v_exp_f32 v226, v226
    v_exp_f32 v227, v227
    v_exp_f32 v228, v228
    v_exp_f32 v229, v229
    v_add_u32 v240, s33, v99
    v_add_u32 v241, s33, v101
    v_mul_f32 v198, v200, v198
    v_mul_f32 v199, v200, v199
    s_mov_b64 exec, s[42:43]
    ds_write_b64 v240, v[238:239]
    ds_write_b32 v241, v242
    s_mov_b64 exec, -1
    v_cvt_pk_bf16_f32 v198, v198, v199
    v_exp_f32 v190, v190
    v_cvt_pk_bf16_f32 v170, v178, v179
    v_cvt_pk_bf16_f32 v171, v180, v181
    v_cvt_pk_bf16_f32 v172, v182, v183
    v_cvt_pk_bf16_f32 v173, v184, v185
    v_exp_f32 v186, v186
    v_exp_f32 v187, v187
    v_exp_f32 v188, v188
    v_exp_f32 v189, v189
    v_exp_f32 v234, v234
    v_cvt_pk_bf16_f32 v162, v222, v223
    v_cvt_pk_bf16_f32 v163, v224, v225
    v_cvt_pk_bf16_f32 v164, v226, v227
    v_cvt_pk_bf16_f32 v165, v228, v229
    v_exp_f32 v230, v230
    v_exp_f32 v231, v231
    v_exp_f32 v232, v232
    v_exp_f32 v233, v233
    v_mul_f32 v194, v200, v194
    v_mul_f32 v195, v200, v195
    v_mul_f32 v196, v200, v196
    v_mul_f32 v197, v200, v197
    ds_write_b32 v101, v198
    v_cvt_pk_bf16_f32 v194, v194, v195
    v_mfma_f32_16x16x32_bf16 v[242:245], v[154:157], v[170:173], 0
    v_cvt_pk_bf16_f32 v195, v196, v197
    v_cvt_pk_bf16_f32 v176, v190, 0
    v_mfma_f32_16x16x32_bf16 v[198:201], v[154:157], v[162:165], 0
    v_cvt_pk_bf16_f32 v174, v186, v187
    v_cvt_pk_bf16_f32 v175, v188, v189
    v_cvt_pk_bf16_f32 v168, v234, 0
    v_cvt_pk_bf16_f32 v166, v230, v231
    v_cvt_pk_bf16_f32 v167, v232, v233
    ds_write_b64 v99, v[194:195]
    v_mfma_f32_16x16x32_bf16 v[238:241], v[146:149], v[170:173], 0
    v_mfma_f32_16x16x32_bf16 v[242:245], v[158:161], v[174:177], v[242:245]
    v_mfma_f32_16x16x32_bf16 v[194:197], v[146:149], v[162:165], 0
    v_mfma_f32_16x16x32_bf16 v[198:201], v[158:161], v[166:169], v[198:201]
    s_nop 5
    v_rcp_f32 v244, v244
    v_mfma_f32_16x16x32_bf16 v[238:241], v[150:153], v[174:177], v[238:241]
    v_mul_f32 v242, v244, v242
    v_mul_f32 v243, v244, v243
    v_mfma_f32_16x16x32_bf16 v[194:197], v[150:153], v[166:169], v[194:197]
    v_rcp_f32 v200, v200
    v_cvt_pk_bf16_f32 v242, v242, v243
    v_mul_f32 v198, v200, v198
    s_nop 1
    v_mul_f32 v238, v244, v238
    v_mul_f32 v239, v244, v239
    v_mul_f32 v240, v244, v240
    v_mul_f32 v241, v244, v241
    v_mul_f32 v194, v200, v194
    v_mul_f32 v195, v200, v195
    v_mul_f32 v199, v200, v199
    v_mul_f32 v196, v200, v196
    v_mul_f32 v197, v200, v197
    v_cvt_pk_bf16_f32 v238, v238, v239
    v_cvt_pk_bf16_f32 v194, v194, v195
    v_cvt_pk_bf16_f32 v239, v240, v241
    v_cvt_pk_bf16_f32 v198, v198, v199
    v_cvt_pk_bf16_f32 v195, v196, v197
    ds_write_b32 v101, v242 offset:3072
    ds_write_b64 v99, v[238:239] offset:3072
    ds_write_b32 v101, v198 offset:6144
    ds_write_b64 v99, v[194:195] offset:6144
    s_waitcnt vmcnt(0)
    s_branch L_p1done
L_spin:
    ds_read_b64 v[162:163], v107
L_spin1:
    s_waitcnt lgkmcnt(0)
    v_readfirstlane_b32 s44, v162
    v_readfirstlane_b32 s45, v163
    s_cmp_lt_u32 s44, s78
    s_nop 3
    s_cbranch_scc1 L_spin
    s_cmp_lt_u32 s45, 8
    s_cbranch_scc1 L_spin
L_top:
    s_setprio 1
    s_cmp_eq_u32 s19, 5
    s_cbranch_scc1 L_pads5
L_pads5r:
    s_cmp_eq_u32 s40, 3
    s_cbranch_scc1 L_t3
    s_cmp_eq_u32 s19, 6
    s_cbranch_scc1 L_last
    s_cmp_lg_u32 s30, 0
    s_cbranch_scc1 L_p2only
    ds_read_b128 v[162:165], v109
    ds_read_b128 v[174:177], v110
    ds_read_b128 v[178:181], v110 offset:3072
    ds_read_b128 v[166:169], v109 offset:16
    ds_read_b128 v[126:129], v110 offset:1024
    ds_read_b128 v[182:185], v110 offset:4096
    ds_read_b128 v[170:173], v109 offset:32
    ds_read_b128 v[142:145], v110 offset:2048
    ds_read_b128 v[186:189], v110 offset:5120
    s_waitcnt lgkmcnt(7)
    v_mfma_f32_16x16x32_bf16 v[222:225], v[174:177], v[162:165], 0
    ds_read_b128 v[174:177], v110 offset:6144
    s_waitcnt lgkmcnt(7)
    v_mfma_f32_16x16x32_bf16 v[226:229], v[178:181], v[162:165], 0
    ds_read_b128 v[178:181], v110 offset:9216
    ds_read_b128 v[190:193], v97
    s_waitcnt lgkmcnt(7)
    v_mfma_f32_16x16x32_bf16 v[222:225], v[126:129], v[166:169], v[222:225]
    ds_read_b128 v[126:129], v110 offset:7168
    s_waitcnt lgkmcnt(7)
    v_mfma_f32_16x16x32_bf16 v[226:229], v[182:185], v[166:169], v[226:229]
    ds_read_b128 v[182:185], v110 offset:10240
    ds_read_b128 v[194:197], v97 offset:1024
    s_waitcnt lgkmcnt(7)
    v_mfma_f32_16x16x32_bf16 v[222:225], v[142:145], v[170:173], v[222:225]
    ds_read_b128 v[142:145], v110 offset:8192
    s_waitcnt lgkmcnt(7)
    v_mfma_f32_16x16x32_bf16 v[226:229], v[186:189], v[170:173], v[226:229]
    ds_read_b128 v[186:189], v110 offset:11264
    s_waitcnt lgkmcnt(7)
    v_mfma_f32_16x16x32_bf16 v[230:233], v[174:177], v[162:165], 0
    ds_read_b128 v[174:177], v110 offset:12288
    s_nop 0
    v_fma_f32 v250, v222, v222, s25
    s_waitcnt lgkmcnt(7)
    v_mfma_f32_16x16x32_bf16 v[234:237], v[178:181], v[162:165], 0
    ds_read_b128 v[178:181], v110 offset:15360
    v_fma_f32 v251, v223, v223, s25
    s_waitcnt lgkmcnt(7)
    v_mfma_f32_16x16x32_bf16 v[202:205], v[0:3], v[190:193], 0
    ds_read_b128 v[198:201], v97 offset:2048
    v_fma_f32 v252, v224, v224, s25
    s_waitcnt lgkmcnt(7)
    v_mfma_f32_16x16x32_bf16 v[230:233], v[126:129], v[166:169], v[230:233]
    ds_read_b128 v[126:129], v110 offset:13312
    v_fma_f32 v253, v225, v225, s25
    s_waitcnt lgkmcnt(7)
    v_mfma_f32_16x16x32_bf16 v[234:237], v[182:185], v[166:169], v[234:237]
    ds_read_b128 v[182:185], v110 offset:16384
    v_fmac_f32 v250, v226, v226
    v_mfma_f32_16x16x32_bf16 v[206:209], v[12:15], v[190:193], 0
    v_fmac_f32 v251, v227, v227
    v_fmac_f32 v252, v228, v228
    s_waitcnt lgkmcnt(6)
    v_mfma_f32_16x16x32_bf16 v[230:233], v[142:145], v[170:173], v[230:233]
    ds_read_b128 v[142:145], v110 offset:14336
    v_fmac_f32 v253, v229, v229
    s_waitcnt lgkmcnt(6)
    v_mfma_f32_16x16x32_bf16 v[234:237], v[186:189], v[170:173], v[234:237]
    ds_read_b128 v[186:189], v110 offset:17408
    s_waitcnt lgkmcnt(6)
    v_mfma_f32_16x16x32_bf16 v[238:241], v[174:177], v[162:165], 0
    ds_read_b32 v111, v111
    v_fmac_f32 v250, v230, v230
    s_waitcnt lgkmcnt(6)
    v_mfma_f32_16x16x32_bf16 v[242:245], v[178:181], v[162:165], 0
    v_fmac_f32 v251, v231, v231
    v_fmac_f32 v252, v232, v232
    v_mfma_f32_16x16x32_bf16 v[210:213], v[24:27], v[190:193], 0
    v_fmac_f32 v253, v233, v233
    v_fmac_f32 v250, v234, v234
    s_waitcnt lgkmcnt(4)
    v_mfma_f32_16x16x32_bf16 v[238:241], v[126:129], v[166:169], v[238:241]
    v_fmac_f32 v251, v235, v235
    v_fmac_f32 v252, v236, v236
    s_waitcnt lgkmcnt(3)
    v_mfma_f32_16x16x32_bf16 v[242:245], v[182:185], v[166:169], v[242:245]
    v_fmac_f32 v253, v237, v237
    ds_read_b128 v[178:181], v97 offset:6144
    v_mfma_f32_16x16x32_bf16 v[202:205], v[4:7], v[194:197], v[202:205]
    ds_read_b128 v[182:185], v97 offset:7168
    s_waitcnt lgkmcnt(4)
    v_mfma_f32_16x16x32_bf16 v[238:241], v[142:145], v[170:173], v[238:241]
    ds_read_b128 v[126:129], v103
    v_mfma_f32_16x16x32_bf16 v[206:209], v[16:19], v[194:197], v[206:209]
    ds_read_b128 v[142:145], v103 offset:64
    s_waitcnt lgkmcnt(5)
    v_mfma_f32_16x16x32_bf16 v[242:245], v[186:189], v[170:173], v[242:245]
    s_nop 2
    v_fmac_f32 v250, v238, v238
    v_mfma_f32_16x16x32_bf16 v[210:213], v[28:31], v[194:197], v[210:213]
    v_fmac_f32 v251, v239, v239
    v_fmac_f32 v252, v240, v240
    v_mfma_f32_16x16x32_bf16 v[202:205], v[8:11], v[198:201], v[202:205]
    v_fmac_f32 v253, v241, v241
    v_fmac_f32 v250, v242, v242
    v_mfma_f32_16x16x32_bf16 v[206:209], v[20:23], v[198:201], v[206:209]
    v_fmac_f32 v251, v243, v243
    v_fmac_f32 v252, v244, v244
    v_mfma_f32_16x16x32_bf16 v[210:213], v[32:35], v[198:201], v[210:213]
    v_fmac_f32 v253, v245, v245
    v_cvt_pk_bf16_f32 v122, v250, v251
    v_mfma_f32_16x16x32_bf16 v[214:217], v[190:193], v[36:39], 0
    v_cvt_pk_bf16_f32 v123, v252, v253
    s_nop 0
    v_fma_f32 v248, v206, v206, s24
    v_mfma_f32_16x16x32_bf16 v[218:221], v[190:193], v[48:51], 0
    ds_read_b128 v[190:193], v97 offset:3072
    v_fma_f32 v249, v207, v207, s24
    v_mfma_f32_16x16x32_bf16 v[214:217], v[194:197], v[40:43], v[214:217]
    v_fma_f32 v246, v202, v202, s24
    v_fma_f32 v247, v203, v203, s24
    v_mfma_f32_16x16x32_bf16 v[218:221], v[194:197], v[52:55], v[218:221]
    ds_read_b128 v[194:197], v97 offset:4096
    v_fmac_f32 v248, v208, v208
    v_mfma_f32_16x16x16_bf16 v[250:253], v[112:113], v[122:123], 0
    v_fmac_f32 v249, v209, v209
    v_fmac_f32 v246, v204, v204
    v_fmac_f32 v247, v205, v205
    v_mfma_f32_16x16x32_bf16 v[214:217], v[198:201], v[44:47], v[214:217]
    v_fmac_f32 v248, v212, v212
    v_fmac_f32 v249, v213, v213
    v_mfma_f32_16x16x32_bf16 v[218:221], v[198:201], v[56:59], v[218:221]
    v_fmac_f32 v246, v210, v210
    v_fmac_f32 v247, v211, v211
    ds_read_b128 v[198:201], v97 offset:5120
    v_cvt_pk_bf16_f32 v254, v246, v247
    v_cvt_pk_bf16_f32 v255, v248, v249
    v_rsq_f32 v251, v251
    ds_read_b128 v[186:189], v97 offset:8192
    v_mfma_f32_16x16x16_bf16 v[246:249], v[112:113], v[254:255], 0
    v_mul_f32 v251, 0x411cc471, v251
    s_mov_b64 exec, s[26:27]
    v_cvt_pk_bf16_f32 v154, v218, v219
    v_cvt_pk_bf16_f32 v155, v220, v221
    s_mov_b64 exec, -1
    v_mul_f32 v222, v251, v222
    v_mul_f32 v223, v251, v223
    v_mul_f32 v224, v251, v224
    v_mul_f32 v225, v251, v225
    v_cvt_pk_bf16_f32 v222, v222, v223
    v_mul_f32 v226, v251, v226
    v_mul_f32 v227, v251, v227
    v_mul_f32 v228, v251, v228
    v_mul_f32 v229, v251, v229
    v_rsq_f32 v246, v246
    v_cvt_pk_bf16_f32 v223, v224, v225
    v_cvt_pk_bf16_f32 v224, v226, v227
    v_cvt_pk_bf16_f32 v225, v228, v229
    v_mul_f32 v230, v251, v230
    v_mul_f32 v231, v251, v231
    v_rsq_f32 v248, v248
    v_mul_f32 v232, v251, v232
    v_mul_f32 v233, v251, v233
    s_waitcnt lgkmcnt(8)
    buffer_store_dwordx4 v[222:225], v111, s[8:11], s21 offen sc1 nt
    v_cvt_pk_bf16_f32 v230, v230, v231
    v_mul_f32 v234, v251, v234
    v_mul_f32 v235, v251, v235
    v_mul_f32 v236, v251, v236
    v_mul_f32 v237, v251, v237
    v_mul_f32 v246, s31, v246
    v_cvt_pk_bf16_f32 v231, v232, v233
    v_cvt_pk_bf16_f32 v232, v234, v235
    v_cvt_pk_bf16_f32 v233, v236, v237
    v_mul_f32 v206, v248, v206
    v_mul_f32 v207, v248, v207
    v_mul_f32 v208, v248, v208
    v_mul_f32 v209, v248, v209
    v_mul_f32 v202, v246, v202
    v_mul_f32 v203, v246, v203
    v_mul_f32 v204, v246, v204
    v_mul_f32 v205, v246, v205
    s_waitcnt lgkmcnt(3)
    v_mfma_f32_16x16x32_bf16 v[222:225], v[0:3], v[190:193], 0
    buffer_store_dwordx4 v[230:233], v111, s[8:11], s21 offen offset:64 sc1 nt
    v_cvt_pk_bf16_f32 v130, v206, v207
    v_mfma_f32_16x16x32_bf16 v[226:229], v[12:15], v[190:193], 0
    v_cvt_pk_bf16_f32 v131, v208, v209
    v_cvt_pk_bf16_f32 v114, v202, v203
    v_cvt_pk_bf16_f32 v115, v204, v205
    v_mfma_f32_16x16x32_bf16 v[202:205], v[0:3], v[178:181], 0
    v_mul_f32 v212, v248, v212
    v_mul_f32 v213, v248, v213
    v_mfma_f32_16x16x32_bf16 v[206:209], v[12:15], v[178:181], 0
    v_mul_f32 v210, v246, v210
    v_mul_f32 v211, v246, v211
    v_mfma_f32_16x16x32_bf16 v[230:233], v[24:27], v[190:193], 0
    v_cvt_pk_bf16_f32 v132, v212, v213
    v_cvt_pk_bf16_f32 v116, v210, v211
    s_waitcnt lgkmcnt(2)
    v_mfma_f32_16x16x32_bf16 v[222:225], v[4:7], v[194:197], v[222:225]
    v_mul_f32 v238, v251, v238
    v_mul_f32 v239, v251, v239
    v_mfma_f32_16x16x32_bf16 v[226:229], v[16:19], v[194:197], v[226:229]
    v_mul_f32 v240, v251, v240
    v_mul_f32 v241, v251, v241
    v_mfma_f32_16x16x32_bf16 v[210:213], v[24:27], v[178:181], 0
    v_mul_f32 v242, v251, v242
    v_mul_f32 v243, v251, v243
    v_mfma_f32_16x16x32_bf16 v[202:205], v[4:7], v[182:185], v[202:205]
    v_mul_f32 v244, v251, v244
    v_mul_f32 v245, v251, v245
    v_mfma_f32_16x16x32_bf16 v[206:209], v[16:19], v[182:185], v[206:209]
    v_cvt_pk_bf16_f32 v238, v238, v239
    v_cvt_pk_bf16_f32 v239, v240, v241
    v_mfma_f32_16x16x32_bf16 v[230:233], v[28:31], v[194:197], v[230:233]
    v_cvt_pk_bf16_f32 v241, v244, v245
    v_cvt_pk_bf16_f32 v146, v214, v215
    s_waitcnt lgkmcnt(1)
    v_mfma_f32_16x16x32_bf16 v[222:225], v[8:11], v[198:201], v[222:225]
    v_cvt_pk_bf16_f32 v147, v216, v217
    v_cvt_pk_bf16_f32 v240, v242, v243
    v_mfma_f32_16x16x32_bf16 v[226:229], v[20:23], v[198:201], v[226:229]
    buffer_store_dwordx4 v[238:241], v111, s[8:11], s21 offen offset:128 sc1 nt
    ds_read_u16 v160, v105 offset:264
    v_mfma_f32_16x16x32_bf16 v[210:213], v[28:31], v[182:185], v[210:213]
    ds_read_u16 v152, v105 offset:256
    s_nop 0
    v_fma_f32 v250, v222, v222, s24
    s_waitcnt lgkmcnt(2)
    v_mfma_f32_16x16x32_bf16 v[202:205], v[8:11], v[186:189], v[202:205]
    v_fma_f32 v251, v223, v223, s24
    v_fma_f32 v252, v226, v226, s24
    v_mfma_f32_16x16x32_bf16 v[206:209], v[20:23], v[186:189], v[206:209]
    v_fma_f32 v253, v227, v227, s24
    v_fmac_f32 v252, v228, v228
    v_mfma_f32_16x16x32_bf16 v[230:233], v[32:35], v[198:201], v[230:233]
    v_fmac_f32 v253, v229, v229
    v_fmac_f32 v250, v224, v224
    v_mfma_f32_16x16x32_bf16 v[210:213], v[32:35], v[186:189], v[210:213]
    v_fmac_f32 v251, v225, v225
    s_nop 0
    v_fma_f32 v248, v206, v206, s24
    v_fma_f32 v249, v207, v207, s24
    v_fma_f32 v246, v202, v202, s24
    v_fma_f32 v247, v203, v203, s24
    v_fmac_f32 v252, v232, v232
    v_fmac_f32 v253, v233, v233
    v_fmac_f32 v250, v230, v230
    v_fmac_f32 v251, v231, v231
    v_fmac_f32 v248, v208, v208
    v_fmac_f32 v249, v209, v209
    v_fmac_f32 v246, v204, v204
    v_fmac_f32 v247, v205, v205
    v_cvt_pk_bf16_f32 v244, v250, v251
    v_cvt_pk_bf16_f32 v245, v252, v253
    v_fmac_f32 v248, v212, v212
    v_fmac_f32 v249, v213, v213
    v_fmac_f32 v246, v210, v210
    v_fmac_f32 v247, v211, v211
    v_cvt_pk_bf16_f32 v255, v248, v249
    v_cvt_pk_bf16_f32 v254, v246, v247
    v_mfma_f32_16x16x16_bf16 v[250:253], v[112:113], v[244:245], 0
    s_nop 0
    v_mfma_f32_16x16x16_bf16 v[246:249], v[112:113], v[254:255], 0
    v_mfma_f32_16x16x32_bf16 v[214:217], v[178:181], v[36:39], 0
    s_nop 4
    v_rsq_f32 v252, v252
    v_mfma_f32_16x16x32_bf16 v[218:221], v[178:181], v[48:51], 0
    v_rsq_f32 v248, v248
    v_mul_f32 v226, v252, v226
    v_mul_f32 v227, v252, v227
    v_mul_f32 v228, v252, v228
    v_mul_f32 v229, v252, v229
    v_mul_f32 v232, v252, v232
    v_mul_f32 v233, v252, v233
    v_mfma_f32_16x16x32_bf16 v[214:217], v[182:185], v[40:43], v[214:217]
    v_cvt_pk_bf16_f32 v134, v226, v227
    v_cvt_pk_bf16_f32 v135, v228, v229
    v_mfma_f32_16x16x32_bf16 v[218:221], v[182:185], v[52:55], v[218:221]
    v_cvt_pk_bf16_f32 v136, v232, v233
    v_mul_f32 v206, v248, v206
    v_mul_f32 v207, v248, v207
    v_mul_f32 v208, v248, v208
    v_mul_f32 v209, v248, v209
    v_mul_f32 v212, v248, v212
    v_mul_f32 v213, v248, v213
    v_cvt_pk_bf16_f32 v138, v206, v207
    v_cvt_pk_bf16_f32 v139, v208, v209
    v_cvt_pk_bf16_f32 v140, v212, v213
    v_mfma_f32_16x16x32_bf16 v[234:237], v[190:193], v[36:39], 0
    v_rsq_f32 v250, v250
    v_mfma_f32_16x16x32_bf16 v[238:241], v[190:193], v[48:51], 0
    v_mul_f32 v250, s31, v250
    v_rsq_f32 v246, v246
    v_mfma_f32_16x16x32_bf16 v[214:217], v[186:189], v[44:47], v[214:217]
    v_mul_f32 v222, v250, v222
    v_mul_f32 v223, v250, v223
    v_mfma_f32_16x16x32_bf16 v[218:221], v[186:189], v[56:59], v[218:221]
    v_mul_f32 v224, v250, v224
    v_mul_f32 v225, v250, v225
    v_mfma_f32_16x16x32_bf16 v[178:181], v[126:129], v[130:133], v[102:105]
    v_cvt_pk_bf16_f32 v118, v222, v223
    v_cvt_pk_bf16_f32 v119, v224, v225
    v_mfma_f32_16x16x32_bf16 v[182:185], v[126:129], v[134:137], v[104:107]
    v_mul_f32 v230, v250, v230
    v_mul_f32 v231, v250, v231
    v_mfma_f32_16x16x32_bf16 v[190:193], v[126:129], v[142:145], v[108:111]
    v_cvt_pk_bf16_f32 v120, v230, v231
    s_nop 0
    v_exp_f32 v178, v178
    v_mfma_f32_16x16x32_bf16 v[186:189], v[126:129], v[138:141], v[106:109]
    s_nop 0
    v_exp_f32 v182, v182
    v_mfma_f32_16x16x32_bf16 v[234:237], v[194:197], v[40:43], v[234:237]
    s_nop 0
    v_exp_f32 v190, v190
    v_cvt_pk_bf16_f32 v179, v178, v182
    v_mfma_f32_16x16x32_bf16 v[238:241], v[194:197], v[52:55], v[238:241]
    s_nop 0
    v_exp_f32 v186, v186
    ds_write_b16 v105, v179 offset:128
    v_mfma_f32_16x16x32_bf16 v[234:237], v[198:201], v[44:47], v[234:237]
    v_cvt_pk_bf16_f32 v183, v186, v190
    ds_write_b16_d16_hi v105, v179 offset:136
    v_mfma_f32_16x16x32_bf16 v[238:241], v[198:201], v[56:59], v[238:241]
    ds_write_b16 v105, v183 offset:192
    s_mov_b64 exec, s[26:27]
    v_cvt_pk_bf16_f32 v158, v218, v219
    v_cvt_pk_bf16_f32 v159, v220, v221
    s_mov_b64 exec, -1
    ds_write_b16_d16_hi v105, v183 offset:200
    v_mfma_f32_16x16x32_bf16 v[222:225], v[130:133], v[114:117], v[60:63]
    ds_read_b128 v[170:173], v103 offset:128
    v_cvt_pk_bf16_f32 v148, v234, v235
    v_mfma_f32_16x16x32_bf16 v[226:229], v[134:137], v[114:117], v[64:67]
    ds_read_b128 v[174:177], v103 offset:192
    v_cvt_pk_bf16_f32 v149, v236, v237
    v_mfma_f32_16x16x32_bf16 v[234:237], v[142:145], v[114:117], v[96:99]
    s_mov_b64 exec, s[26:27]
    v_cvt_pk_bf16_f32 v156, v238, v239
    v_cvt_pk_bf16_f32 v157, v240, v241
    s_mov_b64 exec, -1
    v_mfma_f32_16x16x32_bf16 v[230:233], v[138:141], v[114:117], v[68:71]
    v_exp_f32 v222, v222
    v_exp_f32 v223, v223
    v_exp_f32 v224, v224
    v_exp_f32 v225, v225
    v_exp_f32 v226, v226
    s_setprio 0
    v_exp_f32 v227, v227
    v_exp_f32 v228, v228
    v_exp_f32 v229, v229
    s_waitcnt lgkmcnt(1)
    v_mfma_f32_16x16x32_bf16 v[242:245], v[154:157], v[170:173], 0
    v_exp_f32 v234, v234
    v_cvt_pk_bf16_f32 v162, v222, v223
    v_cvt_pk_bf16_f32 v163, v224, v225
    v_cvt_pk_bf16_f32 v164, v226, v227
    v_cvt_pk_bf16_f32 v165, v228, v229
    v_exp_f32 v230, v230
    v_exp_f32 v231, v231
    v_exp_f32 v232, v232
    v_exp_f32 v233, v233
    v_mul_f32 v246, s31, v246
    v_mfma_f32_16x16x32_bf16 v[238:241], v[146:149], v[170:173], 0
    v_cvt_pk_bf16_f32 v150, v214, v215
    v_cvt_pk_bf16_f32 v151, v216, v217
    s_waitcnt lgkmcnt(0)
    v_mfma_f32_16x16x32_bf16 v[242:245], v[158:161], v[174:177], v[242:245]
    v_mul_f32 v202, v246, v202
    v_mul_f32 v203, v246, v203
    v_mfma_f32_16x16x32_bf16 v[198:201], v[154:157], v[162:165], 0
    v_mul_f32 v204, v246, v204
    v_mul_f32 v205, v246, v205
    v_mul_f32 v210, v246, v210
    v_mul_f32 v211, v246, v211
    v_cvt_pk_bf16_f32 v168, v234, 0
    v_cvt_pk_bf16_f32 v166, v230, v231
    v_cvt_pk_bf16_f32 v167, v232, v233
    v_cvt_pk_bf16_f32 v122, v202, v203
    v_cvt_pk_bf16_f32 v123, v204, v205
    v_cvt_pk_bf16_f32 v124, v210, v211
    v_mfma_f32_16x16x32_bf16 v[238:241], v[150:153], v[174:177], v[238:241]
    v_rcp_f32 v244, v244
    v_mfma_f32_16x16x32_bf16 v[198:201], v[158:161], v[166:169], v[198:201]
    v_mul_f32 v242, v244, v242
    v_mul_f32 v243, v244, v243
    v_mfma_f32_16x16x32_bf16 v[178:181], v[130:133], v[118:121], v[72:75]
    v_cvt_pk_bf16_f32 v242, v242, v243
    s_nop 1
    v_mul_f32 v238, v244, v238
    v_mfma_f32_16x16x32_bf16 v[182:185], v[134:137], v[118:121], v[76:79]
    v_mul_f32 v239, v244, v239
    v_rcp_f32 v200, v200
    v_mfma_f32_16x16x32_bf16 v[222:225], v[130:133], v[122:125], v[84:87]
    v_mul_f32 v240, v244, v240
    v_mul_f32 v241, v244, v241
    v_mfma_f32_16x16x32_bf16 v[226:229], v[134:137], v[122:125], v[88:91]
    v_cvt_pk_bf16_f32 v238, v238, v239
    v_cvt_pk_bf16_f32 v239, v240, v241
    v_mfma_f32_16x16x32_bf16 v[194:197], v[146:149], v[162:165], 0
    v_exp_f32 v178, v178
    v_mfma_f32_16x16x32_bf16 v[190:193], v[142:145], v[118:121], v[98:101]
    v_exp_f32 v179, v179
    v_mfma_f32_16x16x32_bf16 v[186:189], v[138:141], v[118:121], v[80:83]
    v_exp_f32 v180, v180
    v_mfma_f32_16x16x32_bf16 v[234:237], v[142:145], v[122:125], v[100:103]
    v_exp_f32 v181, v181
    v_mfma_f32_16x16x32_bf16 v[230:233], v[138:141], v[122:125], v[92:95]
    v_exp_f32 v182, v182
    v_mfma_f32_16x16x32_bf16 v[194:197], v[150:153], v[166:169], v[194:197]
    v_exp_f32 v183, v183
    v_exp_f32 v184, v184
    v_exp_f32 v185, v185
    v_exp_f32 v222, v222
    v_exp_f32 v223, v223
    v_exp_f32 v224, v224
    v_exp_f32 v225, v225
    v_exp_f32 v226, v226
    v_exp_f32 v227, v227
    v_exp_f32 v228, v228
    v_exp_f32 v229, v229
    v_add_u32 v240, s33, v99
    v_add_u32 v241, s33, v101
    v_mul_f32 v198, v200, v198
    v_mul_f32 v199, v200, v199
    s_mov_b64 exec, s[42:43]
    ds_write_b64 v240, v[238:239]
    ds_write_b32 v241, v242
    s_mov_b64 exec, -1
    v_cvt_pk_bf16_f32 v198, v198, v199
    v_exp_f32 v190, v190
    v_cvt_pk_bf16_f32 v170, v178, v179
    v_cvt_pk_bf16_f32 v171, v180, v181
    v_cvt_pk_bf16_f32 v172, v182, v183
    v_cvt_pk_bf16_f32 v173, v184, v185
    v_exp_f32 v186, v186
    v_exp_f32 v187, v187
    v_exp_f32 v188, v188
    v_exp_f32 v189, v189
    v_exp_f32 v234, v234
    v_cvt_pk_bf16_f32 v162, v222, v223
    v_cvt_pk_bf16_f32 v163, v224, v225
    v_cvt_pk_bf16_f32 v164, v226, v227
    v_cvt_pk_bf16_f32 v165, v228, v229
    v_exp_f32 v230, v230
    v_exp_f32 v231, v231
    v_exp_f32 v232, v232
    v_exp_f32 v233, v233
    v_mul_f32 v194, v200, v194
    v_mul_f32 v195, v200, v195
    v_mul_f32 v196, v200, v196
    v_mul_f32 v197, v200, v197
    ds_write_b32 v101, v198
    v_cvt_pk_bf16_f32 v194, v194, v195
    v_mfma_f32_16x16x32_bf16 v[242:245], v[154:157], v[170:173], 0
    v_cvt_pk_bf16_f32 v195, v196, v197
    v_cvt_pk_bf16_f32 v176, v190, 0
    v_mfma_f32_16x16x32_bf16 v[198:201], v[154:157], v[162:165], 0
    v_cvt_pk_bf16_f32 v174, v186, v187
    v_cvt_pk_bf16_f32 v175, v188, v189
    v_cvt_pk_bf16_f32 v168, v234, 0
    v_cvt_pk_bf16_f32 v166, v230, v231
    v_cvt_pk_bf16_f32 v167, v232, v233
    ds_write_b64 v99, v[194:195]
    v_mfma_f32_16x16x32_bf16 v[238:241], v[146:149], v[170:173], 0
    v_mfma_f32_16x16x32_bf16 v[242:245], v[158:161], v[174:177], v[242:245]
    v_mfma_f32_16x16x32_bf16 v[194:197], v[146:149], v[162:165], 0
    v_mfma_f32_16x16x32_bf16 v[198:201], v[158:161], v[166:169], v[198:201]
    s_nop 5
    v_rcp_f32 v244, v244
    v_mfma_f32_16x16x32_bf16 v[238:241], v[150:153], v[174:177], v[238:241]
    v_mul_f32 v242, v244, v242
    v_mul_f32 v243, v244, v243
    v_mfma_f32_16x16x32_bf16 v[194:197], v[150:153], v[166:169], v[194:197]
    v_rcp_f32 v200, v200
    v_cvt_pk_bf16_f32 v242, v242, v243
    v_mul_f32 v198, v200, v198
    s_nop 1
    v_mul_f32 v238, v244, v238
    v_mul_f32 v239, v244, v239
    v_mul_f32 v240, v244, v240
    v_mul_f32 v241, v244, v241
    v_mul_f32 v194, v200, v194
    v_mul_f32 v195, v200, v195
    v_mul_f32 v199, v200, v199
    v_mul_f32 v196, v200, v196
    v_mul_f32 v197, v200, v197
    v_cvt_pk_bf16_f32 v238, v238, v239
    v_cvt_pk_bf16_f32 v194, v194, v195
    v_cvt_pk_bf16_f32 v239, v240, v241
    v_cvt_pk_bf16_f32 v198, v198, v199
    v_cvt_pk_bf16_f32 v195, v196, v197
    ds_write_b32 v101, v242 offset:3072
    ds_write_b64 v99, v[238:239] offset:3072
    ds_write_b32 v101, v198 offset:6144
    ds_write_b64 v99, v[194:195] offset:6144
    s_waitcnt vmcnt(3)
L_p1done:
    v_mov_b32 v167, 1
    s_mov_b64 exec, 1
    ds_add_u32 v107, v167
    s_mov_b64 exec, -1
    ds_read_b64 v[162:163], v107
    s_add_u32 s78, s78, 4
    s_add_u32 s19, s19, 1
    s_add_u32 s36, s36, 9216
    s_cmp_eq_u32 s36, s73
    s_cselect_b32 s23, 27648, 0
    s_sub_u32 s36, s36, s23
    s_sub_u32 s23, s36, 59136
    v_add_u32 v97, s23, v110
    s_add_u32 s79, s79, 9216
    s_cmp_eq_u32 s79, s73
    s_cselect_b32 s23, 27648, 0
    s_sub_u32 s79, s79, s23
    v_add_u32 v99, s32, v99
    v_add_u32 v101, s32, v101
    v_add_u32 v103, 320, v103
    v_add_u32 v105, 320, v105
    s_sub_u32 s32, 0, s32
    s_add_u32 s21, s21, 1344
    s_add_u32 s40, s16, s19
    s_add_u32 s40, s40, 3
    s_and_b32 s40, s40, 3
    v_subrev_u32 v111, 59136, v110
    s_add_u32 s20, s20, 1344
    v_lshrrev_b32 v111, 2, v111
    s_lshl_b64 s[42:43], s[28:29], s19
    s_ashr_i32 s33, s32, 1
    s_add_u32 s33, s33, 3072
    s_mul_i32 s22, s40, 3072
    s_add_u32 s22, s22, s32
    s_sub_u32 s22, s22, s37
    v_add_u32 v109, s22, v99
    s_lshl_b32 s23, s40, 8
    s_cmp_eq_u32 s40, 3
    s_cselect_b32 s23, 0, s23
    s_cselect_b32 s38, 3, 6
    s_add_u32 s23, s23, s76
    s_cmp_eq_u32 s19, s38
    s_cselect_b32 s38, 1024, 0
    s_cselect_b32 s22, 0, s20
    s_add_u32 s23, s23, s38
    v_add_u32 v111, s23, v111
    s_mov_b32 m0, s79
    s_nop 0
    s_branch L_spin1
L_t3:
    s_cmp_eq_u32 s19, 6
    s_cbranch_scc1 L_p2x
    s_cmp_lt_u32 s19, 4
    s_cbranch_scc1 L_dodma
L_nodma:
    s_mov_b32 m0, 0x30000
    s_mov_b32 s22, 0x40000000
L_dodma:
    s_add_u32 s38, s22, 64
    s_add_u32 s39, s22, 128
L_p1:
    s_cmp_lg_u32 s30, 0
    s_cbranch_scc1 L_p1slow
    ds_read_b128 v[178:181], v97
    ds_read_b128 v[182:185], v97 offset:1024
    ds_read_b128 v[186:189], v97 offset:2048
    ds_read_b128 v[190:193], v97 offset:3072
    ds_read_b128 v[194:197], v97 offset:4096
    ds_read_b128 v[198:201], v97 offset:5120
    ds_read_b128 v[126:129], v103
    ds_read_b128 v[142:145], v103 offset:64
    s_waitcnt lgkmcnt(7)
    v_mfma_f32_16x16x32_bf16 v[202:205], v[0:3], v[178:181], 0
    ds_read_b32 v162, v111
    ds_read_b32 v163, v111 offset:256
    v_mfma_f32_16x16x32_bf16 v[206:209], v[12:15], v[178:181], 0
    ds_read_b32 v164, v111 offset:512
    ds_read_u16 v160, v105 offset:264
    v_mfma_f32_16x16x32_bf16 v[210:213], v[24:27], v[178:181], 0
    ds_read_u16 v152, v105 offset:256
    s_waitcnt lgkmcnt(11)
    v_mfma_f32_16x16x32_bf16 v[202:205], v[4:7], v[182:185], v[202:205]
    v_mfma_f32_16x16x32_bf16 v[206:209], v[16:19], v[182:185], v[206:209]
    v_mfma_f32_16x16x32_bf16 v[210:213], v[28:31], v[182:185], v[210:213]
    s_waitcnt lgkmcnt(10)
    v_mfma_f32_16x16x32_bf16 v[202:205], v[8:11], v[186:189], v[202:205]
    v_mfma_f32_16x16x32_bf16 v[206:209], v[20:23], v[186:189], v[206:209]
    s_waitcnt lgkmcnt(4)
    buffer_load_dwordx4 v162, s[4:7], s22 offen lds
    s_add_u32 m0, m0, 1024
    v_mfma_f32_16x16x32_bf16 v[210:213], v[32:35], v[186:189], v[210:213]
    s_nop 2
    v_fma_f32 v246, v202, v202, s24
    v_fma_f32 v247, v203, v203, s24
    v_mfma_f32_16x16x32_bf16 v[214:217], v[178:181], v[36:39], 0
    v_fma_f32 v248, v206, v206, s24
    v_fma_f32 v249, v207, v207, s24
    v_mfma_f32_16x16x32_bf16 v[218:221], v[178:181], v[48:51], 0
    ds_read_b128 v[178:181], v97 offset:6144
    v_fmac_f32 v248, v208, v208
    v_mfma_f32_16x16x32_bf16 v[214:217], v[182:185], v[40:43], v[214:217]
    v_fmac_f32 v249, v209, v209
    v_fmac_f32 v246, v204, v204
    v_mfma_f32_16x16x32_bf16 v[218:221], v[182:185], v[52:55], v[218:221]
    v_fmac_f32 v247, v205, v205
    ds_read_b128 v[182:185], v97 offset:7168
    v_fmac_f32 v248, v212, v212
    v_fmac_f32 v249, v213, v213
    v_fmac_f32 v246, v210, v210
    v_fmac_f32 v247, v211, v211
    v_mfma_f32_16x16x32_bf16 v[214:217], v[186:189], v[44:47], v[214:217]
    v_cvt_pk_bf16_f32 v254, v246, v247
    v_cvt_pk_bf16_f32 v255, v248, v249
    v_mfma_f32_16x16x32_bf16 v[218:221], v[186:189], v[56:59], v[218:221]
    ds_read_b128 v[186:189], v97 offset:8192
    buffer_load_dwordx4 v162, s[4:7], s38 offen lds
    s_add_u32 m0, m0, 1024
    v_mfma_f32_16x16x16_bf16 v[246:249], v[112:113], v[254:255], 0
    s_nop 0
    v_cvt_pk_bf16_f32 v146, v214, v215
    v_cvt_pk_bf16_f32 v147, v216, v217
    v_mfma_f32_16x16x32_bf16 v[222:225], v[0:3], v[190:193], 0
    s_mov_b64 exec, s[26:27]
    v_cvt_pk_bf16_f32 v154, v218, v219
    v_cvt_pk_bf16_f32 v155, v220, v221
    s_mov_b64 exec, -1
    v_mfma_f32_16x16x32_bf16 v[226:229], v[12:15], v[190:193], 0
    v_rsq_f32 v246, v246
    v_rsq_f32 v248, v248
    v_mul_f32 v246, s31, v246
    v_mfma_f32_16x16x32_bf16 v[230:233], v[24:27], v[190:193], 0
    v_mul_f32 v206, v248, v206
    v_mul_f32 v207, v248, v207
    v_mul_f32 v208, v248, v208
    v_mul_f32 v209, v248, v209
    v_mul_f32 v202, v246, v202
    v_mul_f32 v203, v246, v203
    v_mul_f32 v204, v246, v204
    v_mul_f32 v205, v246, v205
    v_cvt_pk_bf16_f32 v130, v206, v207
    v_cvt_pk_bf16_f32 v131, v208, v209
    v_cvt_pk_bf16_f32 v114, v202, v203
    v_cvt_pk_bf16_f32 v115, v204, v205
    s_waitcnt lgkmcnt(2)
    v_mfma_f32_16x16x32_bf16 v[202:205], v[0:3], v[178:181], 0
    v_mul_f32 v212, v248, v212
    v_mul_f32 v213, v248, v213
    v_mfma_f32_16x16x32_bf16 v[206:209], v[12:15], v[178:181], 0
    v_mul_f32 v210, v246, v210
    v_mul_f32 v211, v246, v211
    v_mfma_f32_16x16x32_bf16 v[222:225], v[4:7], v[194:197], v[222:225]
    v_cvt_pk_bf16_f32 v132, v212, v213
    v_cvt_pk_bf16_f32 v116, v210, v211
    v_mfma_f32_16x16x32_bf16 v[226:229], v[16:19], v[194:197], v[226:229]
    buffer_load_dwordx4 v162, s[4:7], s39 offen lds
    s_add_u32 m0, m0, 1024
    v_mfma_f32_16x16x32_bf16 v[210:213], v[24:27], v[178:181], 0
    s_waitcnt lgkmcnt(1)
    v_mfma_f32_16x16x32_bf16 v[202:205], v[4:7], v[182:185], v[202:205]
    v_mfma_f32_16x16x32_bf16 v[206:209], v[16:19], v[182:185], v[206:209]
    v_mfma_f32_16x16x32_bf16 v[230:233], v[28:31], v[194:197], v[230:233]
    v_mfma_f32_16x16x32_bf16 v[222:225], v[8:11], v[198:201], v[222:225]
    buffer_load_dwordx4 v163, s[4:7], s22 offen lds
    s_add_u32 m0, m0, 1024
    v_mfma_f32_16x16x32_bf16 v[226:229], v[20:23], v[198:201], v[226:229]
    v_mfma_f32_16x16x32_bf16 v[210:213], v[28:31], v[182:185], v[210:213]
    s_nop 3
    v_fma_f32 v250, v222, v222, s24
    s_waitcnt lgkmcnt(0)
    v_mfma_f32_16x16x32_bf16 v[202:205], v[8:11], v[186:189], v[202:205]
    v_fma_f32 v251, v223, v223, s24
    v_fma_f32 v252, v226, v226, s24
    v_mfma_f32_16x16x32_bf16 v[206:209], v[20:23], v[186:189], v[206:209]
    v_fma_f32 v253, v227, v227, s24
    v_fmac_f32 v252, v228, v228
    v_mfma_f32_16x16x32_bf16 v[230:233], v[32:35], v[198:201], v[230:233]
    v_fmac_f32 v253, v229, v229
    v_fmac_f32 v250, v224, v224
    v_mfma_f32_16x16x32_bf16 v[210:213], v[32:35], v[186:189], v[210:213]
    v_fmac_f32 v251, v225, v225
    s_nop 0
    v_fma_f32 v248, v206, v206, s24
    v_fma_f32 v249, v207, v207, s24
    v_fma_f32 v246, v202, v202, s24
    v_fma_f32 v247, v203, v203, s24
    v_fmac_f32 v252, v232, v232
    v_fmac_f32 v253, v233, v233
    v_fmac_f32 v250, v230, v230
    v_fmac_f32 v251, v231, v231
    v_fmac_f32 v248, v208, v208
    v_fmac_f32 v249, v209, v209
    v_fmac_f32 v246, v204, v204
    v_fmac_f32 v247, v205, v205
    v_cvt_pk_bf16_f32 v244, v250, v251
    v_cvt_pk_bf16_f32 v245, v252, v253
    v_fmac_f32 v248, v212, v212
    v_fmac_f32 v249, v213, v213
    v_fmac_f32 v246, v210, v210
    v_fmac_f32 v247, v211, v211
    v_cvt_pk_bf16_f32 v255, v248, v249
    v_cvt_pk_bf16_f32 v254, v246, v247
    v_mfma_f32_16x16x16_bf16 v[250:253], v[112:113], v[244:245], 0
    buffer_load_dwordx4 v163, s[4:7], s38 offen lds
    s_add_u32 m0, m0, 1024
    v_mfma_f32_16x16x16_bf16 v[246:249], v[112:113], v[254:255], 0
    v_mfma_f32_16x16x32_bf16 v[214:217], v[178:181], v[36:39], 0
    s_nop 3
    v_rsq_f32 v252, v252
    v_mfma_f32_16x16x32_bf16 v[218:221], v[178:181], v[48:51], 0
    s_nop 0
    v_rsq_f32 v248, v248
    v_mul_f32 v226, v252, v226
    v_mul_f32 v227, v252, v227
    v_mul_f32 v228, v252, v228
    v_mul_f32 v229, v252, v229
    v_mul_f32 v232, v252, v232
    v_mul_f32 v233, v252, v233
    v_mfma_f32_16x16x32_bf16 v[214:217], v[182:185], v[40:43], v[214:217]
    v_cvt_pk_bf16_f32 v134, v226, v227
    v_cvt_pk_bf16_f32 v135, v228, v229
    v_mfma_f32_16x16x32_bf16 v[218:221], v[182:185], v[52:55], v[218:221]
    v_cvt_pk_bf16_f32 v136, v232, v233
    v_mul_f32 v206, v248, v206
    v_mul_f32 v207, v248, v207
    v_mul_f32 v208, v248, v208
    v_mul_f32 v209, v248, v209
    v_mul_f32 v212, v248, v212
    v_mul_f32 v213, v248, v213
    v_cvt_pk_bf16_f32 v138, v206, v207
    v_cvt_pk_bf16_f32 v139, v208, v209
    v_cvt_pk_bf16_f32 v140, v212, v213
    v_mfma_f32_16x16x32_bf16 v[234:237], v[190:193], v[36:39], 0
    v_rsq_f32 v250, v250
    v_mfma_f32_16x16x32_bf16 v[238:241], v[190:193], v[48:51], 0
    v_mul_f32 v250, s31, v250
    buffer_load_dwordx4 v163, s[4:7], s39 offen lds
    s_add_u32 m0, m0, 1024
    v_mfma_f32_16x16x32_bf16 v[214:217], v[186:189], v[44:47], v[214:217]
    v_mul_f32 v222, v250, v222
    v_mul_f32 v223, v250, v223
    v_mfma_f32_16x16x32_bf16 v[218:221], v[186:189], v[56:59], v[218:221]
    v_mul_f32 v224, v250, v224
    v_mul_f32 v225, v250, v225
    v_mfma_f32_16x16x32_bf16 v[178:181], v[126:129], v[130:133], v[102:105]
    v_cvt_pk_bf16_f32 v118, v222, v223
    v_cvt_pk_bf16_f32 v119, v224, v225
    v_mfma_f32_16x16x32_bf16 v[182:185], v[126:129], v[134:137], v[104:107]
    v_mul_f32 v230, v250, v230
    v_mul_f32 v231, v250, v231
    v_mfma_f32_16x16x32_bf16 v[190:193], v[126:129], v[142:145], v[108:111]
    v_cvt_pk_bf16_f32 v120, v230, v231
    s_nop 0
    v_exp_f32 v178, v178
    v_mfma_f32_16x16x32_bf16 v[186:189], v[126:129], v[138:141], v[106:109]
    s_nop 0
    v_exp_f32 v182, v182
    v_mfma_f32_16x16x32_bf16 v[234:237], v[194:197], v[40:43], v[234:237]
    s_nop 0
    v_exp_f32 v190, v190
    v_cvt_pk_bf16_f32 v179, v178, v182
    v_mfma_f32_16x16x32_bf16 v[238:241], v[194:197], v[52:55], v[238:241]
    s_nop 0
    v_exp_f32 v186, v186
    ds_write_b16 v105, v179 offset:128
    v_mfma_f32_16x16x32_bf16 v[234:237], v[198:201], v[44:47], v[234:237]
    v_cvt_pk_bf16_f32 v183, v186, v190
    ds_write_b16_d16_hi v105, v179 offset:136
    v_mfma_f32_16x16x32_bf16 v[238:241], v[198:201], v[56:59], v[238:241]
    ds_write_b16 v105, v183 offset:192
    buffer_load_dwordx4 v164, s[4:7], s22 offen lds
    s_add_u32 m0, m0, 1024
    ds_write_b16_d16_hi v105, v183 offset:200
    v_mfma_f32_16x16x32_bf16 v[222:225], v[130:133], v[114:117], v[60:63]
    ds_read_b128 v[170:173], v103 offset:128
    v_cvt_pk_bf16_f32 v148, v234, v235
    v_mfma_f32_16x16x32_bf16 v[226:229], v[134:137], v[114:117], v[64:67]
    ds_read_b128 v[174:177], v103 offset:192
    v_cvt_pk_bf16_f32 v149, v236, v237
    v_mfma_f32_16x16x32_bf16 v[234:237], v[142:145], v[114:117], v[96:99]
    s_mov_b64 exec, s[26:27]
    v_cvt_pk_bf16_f32 v156, v238, v239
    v_cvt_pk_bf16_f32 v157, v240, v241
    s_mov_b64 exec, -1
    v_mfma_f32_16x16x32_bf16 v[230:233], v[138:141], v[114:117], v[68:71]
    s_mov_b64 exec, s[26:27]
    v_cvt_pk_bf16_f32 v158, v218, v219
    v_cvt_pk_bf16_f32 v159, v220, v221
    s_mov_b64 exec, -1
    buffer_load_dwordx4 v164, s[4:7], s38 offen lds
    s_add_u32 m0, m0, 1024
    v_exp_f32 v222, v222
    v_exp_f32 v223, v223
    v_exp_f32 v224, v224
    v_exp_f32 v225, v225
    v_exp_f32 v226, v226
    s_setprio 0
    v_exp_f32 v227, v227
    v_exp_f32 v228, v228
    v_exp_f32 v229, v229
    v_rsq_f32 v246, v246
    buffer_load_dwordx4 v164, s[4:7], s39 offen lds
    s_add_u32 m0, m0, 1024
    s_waitcnt lgkmcnt(1)
    v_mfma_f32_16x16x32_bf16 v[242:245], v[154:157], v[170:173], 0
    v_exp_f32 v234, v234
    v_cvt_pk_bf16_f32 v162, v222, v223
    v_cvt_pk_bf16_f32 v163, v224, v225
    v_cvt_pk_bf16_f32 v164, v226, v227
    v_cvt_pk_bf16_f32 v165, v228, v229
    v_exp_f32 v230, v230
    v_exp_f32 v231, v231
    v_exp_f32 v232, v232
    v_exp_f32 v233, v233
    v_mul_f32 v246, s31, v246
    v_mfma_f32_16x16x32_bf16 v[238:241], v[146:149], v[170:173], 0
    v_cvt_pk_bf16_f32 v150, v214, v215
    v_cvt_pk_bf16_f32 v151, v216, v217
    s_waitcnt lgkmcnt(0)
    v_mfma_f32_16x16x32_bf16 v[242:245], v[158:161], v[174:177], v[242:245]
    v_mul_f32 v202, v246, v202
    v_mul_f32 v203, v246, v203
    v_mfma_f32_16x16x32_bf16 v[198:201], v[154:157], v[162:165], 0
    v_mul_f32 v204, v246, v204
    v_mul_f32 v205, v246, v205
    v_mul_f32 v210, v246, v210
    v_mul_f32 v211, v246, v211
    v_cvt_pk_bf16_f32 v168, v234, 0
    v_cvt_pk_bf16_f32 v166, v230, v231
    v_cvt_pk_bf16_f32 v167, v232, v233
    v_cvt_pk_bf16_f32 v122, v202, v203
    v_cvt_pk_bf16_f32 v123, v204, v205
    v_cvt_pk_bf16_f32 v124, v210, v211
    v_mfma_f32_16x16x32_bf16 v[238:241], v[150:153], v[174:177], v[238:241]
    v_rcp_f32 v244, v244
    v_mfma_f32_16x16x32_bf16 v[198:201], v[158:161], v[166:169], v[198:201]
    v_mul_f32 v242, v244, v242
    v_mul_f32 v243, v244, v243
    v_mfma_f32_16x16x32_bf16 v[178:181], v[130:133], v[118:121], v[72:75]
    v_cvt_pk_bf16_f32 v242, v242, v243
    s_nop 1
    v_mul_f32 v238, v244, v238
    v_mfma_f32_16x16x32_bf16 v[182:185], v[134:137], v[118:121], v[76:79]
    v_mul_f32 v239, v244, v239
    v_rcp_f32 v200, v200
    v_mfma_f32_16x16x32_bf16 v[222:225], v[130:133], v[122:125], v[84:87]
    v_mul_f32 v240, v244, v240
    v_mul_f32 v241, v244, v241
    v_mfma_f32_16x16x32_bf16 v[226:229], v[134:137], v[122:125], v[88:91]
    v_cvt_pk_bf16_f32 v238, v238, v239
    v_cvt_pk_bf16_f32 v239, v240, v241
    v_mfma_f32_16x16x32_bf16 v[194:197], v[146:149], v[162:165], 0
    v_exp_f32 v178, v178
    v_mfma_f32_16x16x32_bf16 v[190:193], v[142:145], v[118:121], v[98:101]
    v_exp_f32 v179, v179
    v_mfma_f32_16x16x32_bf16 v[186:189], v[138:141], v[118:121], v[80:83]
    v_exp_f32 v180, v180
    v_mfma_f32_16x16x32_bf16 v[234:237], v[142:145], v[122:125], v[100:103]
    v_exp_f32 v181, v181
    v_mfma_f32_16x16x32_bf16 v[230:233], v[138:141], v[122:125], v[92:95]
    v_exp_f32 v182, v182
    v_mfma_f32_16x16x32_bf16 v[194:197], v[150:153], v[166:169], v[194:197]
    v_exp_f32 v183, v183
    v_exp_f32 v184, v184
    v_exp_f32 v185, v185
    v_exp_f32 v222, v222
    v_exp_f32 v223, v223
    v_exp_f32 v224, v224
    v_exp_f32 v225, v225
    v_exp_f32 v226, v226
    v_exp_f32 v227, v227
    v_exp_f32 v228, v228
    v_exp_f32 v229, v229
    v_add_u32 v240, s33, v99
    v_add_u32 v241, s33, v101
    v_mul_f32 v198, v200, v198
    v_mul_f32 v199, v200, v199
    s_mov_b64 exec, s[42:43]
    ds_write_b64 v240, v[238:239]
    ds_write_b32 v241, v242
    s_mov_b64 exec, -1
    v_cvt_pk_bf16_f32 v198, v198, v199
    v_exp_f32 v190, v190
    v_cvt_pk_bf16_f32 v170, v178, v179
    v_cvt_pk_bf16_f32 v171, v180, v181
    v_cvt_pk_bf16_f32 v172, v182, v183
    v_cvt_pk_bf16_f32 v173, v184, v185
    v_exp_f32 v186, v186
    v_exp_f32 v187, v187
    v_exp_f32 v188, v188
    v_exp_f32 v189, v189
    v_exp_f32 v234, v234
    v_cvt_pk_bf16_f32 v162, v222, v223
    v_cvt_pk_bf16_f32 v163, v224, v225
    v_cvt_pk_bf16_f32 v164, v226, v227
    v_cvt_pk_bf16_f32 v165, v228, v229
    v_exp_f32 v230, v230
    v_exp_f32 v231, v231
    v_exp_f32 v232, v232
    v_exp_f32 v233, v233
    v_mul_f32 v194, v200, v194
    v_mul_f32 v195, v200, v195
    v_mul_f32 v196, v200, v196
    v_mul_f32 v197, v200, v197
    ds_write_b32 v101, v198
    v_cvt_pk_bf16_f32 v194, v194, v195
    v_mfma_f32_16x16x32_bf16 v[242:245], v[154:157], v[170:173], 0
    v_cvt_pk_bf16_f32 v195, v196, v197
    v_cvt_pk_bf16_f32 v176, v190, 0
    v_mfma_f32_16x16x32_bf16 v[198:201], v[154:157], v[162:165], 0
    v_cvt_pk_bf16_f32 v174, v186, v187
    v_cvt_pk_bf16_f32 v175, v188, v189
    v_cvt_pk_bf16_f32 v168, v234, 0
    v_cvt_pk_bf16_f32 v166, v230, v231
    v_cvt_pk_bf16_f32 v167, v232, v233
    ds_write_b64 v99, v[194:195]
    v_mfma_f32_16x16x32_bf16 v[238:241], v[146:149], v[170:173], 0
    v_mfma_f32_16x16x32_bf16 v[242:245], v[158:161], v[174:177], v[242:245]
    v_mfma_f32_16x16x32_bf16 v[194:197], v[146:149], v[162:165], 0
    v_mfma_f32_16x16x32_bf16 v[198:201], v[158:161], v[166:169], v[198:201]
    s_nop 5
    v_rcp_f32 v244, v244
    v_mfma_f32_16x16x32_bf16 v[238:241], v[150:153], v[174:177], v[238:241]
    v_mul_f32 v242, v244, v242
    v_mul_f32 v243, v244, v243
    v_mfma_f32_16x16x32_bf16 v[194:197], v[150:153], v[166:169], v[194:197]
    v_rcp_f32 v200, v200
    v_cvt_pk_bf16_f32 v242, v242, v243
    v_mul_f32 v198, v200, v198
    s_nop 1
    v_mul_f32 v238, v244, v238
    v_mul_f32 v239, v244, v239
    v_mul_f32 v240, v244, v240
    v_mul_f32 v241, v244, v241
    v_mul_f32 v194, v200, v194
    v_mul_f32 v195, v200, v195
    v_mul_f32 v199, v200, v199
    v_mul_f32 v196, v200, v196
    v_mul_f32 v197, v200, v197
    v_cvt_pk_bf16_f32 v238, v238, v239
    v_cvt_pk_bf16_f32 v194, v194, v195
    v_cvt_pk_bf16_f32 v239, v240, v241
    v_cvt_pk_bf16_f32 v198, v198, v199
    v_cvt_pk_bf16_f32 v195, v196, v197
    ds_write_b32 v101, v242 offset:3072
    ds_write_b64 v99, v[238:239] offset:3072
    ds_write_b32 v101, v198 offset:6144
    ds_write_b64 v99, v[194:195] offset:6144
    s_waitcnt vmcnt(9)
    s_branch L_p1done
L_p2x:
    s_add_u32 s22, s77, 9216
    v_subrev_u32 v178, 59136, v110
    v_mul_u32_u24 v109, 3, v178
    v_add_u32 v109, s22, v109
    v_add_u32 v111, 768, v111
    s_nop 1
L_last:
    s_mov_b32 s21, 0
L_p2only:
    ds_read_b128 v[162:165], v109
    ds_read_b128 v[174:177], v110
    ds_read_b128 v[178:181], v110 offset:3072
    ds_read_b128 v[166:169], v109 offset:16
    ds_read_b128 v[126:129], v110 offset:1024
    ds_read_b128 v[182:185], v110 offset:4096
    ds_read_b128 v[170:173], v109 offset:32
    ds_read_b128 v[142:145], v110 offset:2048
    ds_read_b128 v[186:189], v110 offset:5120
    s_waitcnt lgkmcnt(7)
    v_mfma_f32_16x16x32_bf16 v[222:225], v[174:177], v[162:165], 0
    ds_read_b128 v[174:177], v110 offset:6144
    s_waitcnt lgkmcnt(7)
    v_mfma_f32_16x16x32_bf16 v[226:229], v[178:181], v[162:165], 0
    ds_read_b128 v[178:181], v110 offset:9216
    ds_read_b32 v111, v111
    s_waitcnt lgkmcnt(7)
    v_mfma_f32_16x16x32_bf16 v[222:225], v[126:129], v[166:169], v[222:225]
    ds_read_b128 v[126:129], v110 offset:7168
    s_waitcnt lgkmcnt(7)
    v_mfma_f32_16x16x32_bf16 v[226:229], v[182:185], v[166:169], v[226:229]
    ds_read_b128 v[182:185], v110 offset:10240
    s_waitcnt lgkmcnt(6)
    v_mfma_f32_16x16x32_bf16 v[222:225], v[142:145], v[170:173], v[222:225]
    ds_read_b128 v[142:145], v110 offset:8192
    s_waitcnt lgkmcnt(6)
    v_mfma_f32_16x16x32_bf16 v[226:229], v[186:189], v[170:173], v[226:229]
    ds_read_b128 v[186:189], v110 offset:11264
    s_waitcnt lgkmcnt(6)
    v_mfma_f32_16x16x32_bf16 v[230:233], v[174:177], v[162:165], 0
    ds_read_b128 v[174:177], v110 offset:12288
    s_nop 0
    v_fma_f32 v250, v222, v222, s25
    s_waitcnt lgkmcnt(6)
    v_mfma_f32_16x16x32_bf16 v[234:237], v[178:181], v[162:165], 0
    ds_read_b128 v[178:181], v110 offset:15360
    v_fma_f32 v251, v223, v223, s25
    v_fma_f32 v252, v224, v224, s25
    v_fma_f32 v253, v225, v225, s25
    v_fmac_f32 v250, v226, v226
    v_fmac_f32 v251, v227, v227
    s_waitcnt lgkmcnt(5)
    v_mfma_f32_16x16x32_bf16 v[230:233], v[126:129], v[166:169], v[230:233]
    ds_read_b128 v[126:129], v110 offset:13312
    v_fmac_f32 v252, v228, v228
    s_waitcnt lgkmcnt(5)
    v_mfma_f32_16x16x32_bf16 v[234:237], v[182:185], v[166:169], v[234:237]
    ds_read_b128 v[182:185], v110 offset:16384
    v_fmac_f32 v253, v229, v229
    s_waitcnt lgkmcnt(5)
    v_mfma_f32_16x16x32_bf16 v[230:233], v[142:145], v[170:173], v[230:233]
    ds_read_b128 v[142:145], v110 offset:14336
    s_waitcnt lgkmcnt(5)
    v_mfma_f32_16x16x32_bf16 v[234:237], v[186:189], v[170:173], v[234:237]
    ds_read_b128 v[186:189], v110 offset:17408
    s_waitcnt lgkmcnt(5)
    v_mfma_f32_16x16x32_bf16 v[238:241], v[174:177], v[162:165], 0
    s_nop 1
    v_fmac_f32 v250, v230, v230
    s_waitcnt lgkmcnt(4)
    v_mfma_f32_16x16x32_bf16 v[242:245], v[178:181], v[162:165], 0
    v_fmac_f32 v251, v231, v231
    v_fmac_f32 v252, v232, v232
    v_fmac_f32 v253, v233, v233
    v_fmac_f32 v250, v234, v234
    v_fmac_f32 v251, v235, v235
    v_fmac_f32 v252, v236, v236
    s_waitcnt lgkmcnt(3)
    v_mfma_f32_16x16x32_bf16 v[238:241], v[126:129], v[166:169], v[238:241]
    v_fmac_f32 v253, v237, v237
    s_waitcnt lgkmcnt(2)
    v_mfma_f32_16x16x32_bf16 v[242:245], v[182:185], v[166:169], v[242:245]
    s_waitcnt lgkmcnt(1)
    v_mfma_f32_16x16x32_bf16 v[238:241], v[142:145], v[170:173], v[238:241]
    s_waitcnt lgkmcnt(0)
    v_mfma_f32_16x16x32_bf16 v[242:245], v[186:189], v[170:173], v[242:245]
    s_nop 5
    v_fmac_f32 v250, v238, v238
    v_fmac_f32 v251, v239, v239
    v_fmac_f32 v252, v240, v240
    v_fmac_f32 v253, v241, v241
    v_fmac_f32 v250, v242, v242
    v_fmac_f32 v251, v243, v243
    v_fmac_f32 v252, v244, v244
    v_fmac_f32 v253, v245, v245
    v_cvt_pk_bf16_f32 v122, v250, v251
    v_cvt_pk_bf16_f32 v123, v252, v253
    s_nop 1
    v_mfma_f32_16x16x16_bf16 v[250:253], v[112:113], v[122:123], 0
    s_nop 7
    v_rsq_f32 v251, v251
    s_nop 0
    v_mul_f32 v251, 0x411cc471, v251
    v_mul_f32 v222, v251, v222
    v_mul_f32 v223, v251, v223
    v_mul_f32 v224, v251, v224
    v_mul_f32 v225, v251, v225
    v_mul_f32 v230, v251, v230
    v_mul_f32 v231, v251, v231
    v_cvt_pk_bf16_f32 v222, v222, v223
    v_mul_f32 v226, v251, v226
    v_mul_f32 v227, v251, v227
    v_mul_f32 v228, v251, v228
    v_mul_f32 v229, v251, v229
    v_mul_f32 v232, v251, v232
    v_mul_f32 v233, v251, v233
    v_mul_f32 v238, v251, v238
    v_mul_f32 v239, v251, v239
    v_cvt_pk_bf16_f32 v223, v224, v225
    v_cvt_pk_bf16_f32 v230, v230, v231
    v_mul_f32 v234, v251, v234
    v_mul_f32 v235, v251, v235
    v_mul_f32 v236, v251, v236
    v_mul_f32 v237, v251, v237
    v_mul_f32 v240, v251, v240
    v_mul_f32 v241, v251, v241
    v_cvt_pk_bf16_f32 v224, v226, v227
    v_cvt_pk_bf16_f32 v225, v228, v229
    v_cvt_pk_bf16_f32 v231, v232, v233
    v_cvt_pk_bf16_f32 v238, v238, v239
    v_mul_f32 v242, v251, v242
    v_mul_f32 v243, v251, v243
    v_mul_f32 v244, v251, v244
    v_mul_f32 v245, v251, v245
    v_cvt_pk_bf16_f32 v232, v234, v235
    v_cvt_pk_bf16_f32 v233, v236, v237
    v_cvt_pk_bf16_f32 v239, v240, v241
    buffer_store_dwordx4 v[222:225], v111, s[8:11], s21 offen sc1 nt
    v_cvt_pk_bf16_f32 v240, v242, v243
    v_cvt_pk_bf16_f32 v241, v244, v245
    buffer_store_dwordx4 v[230:233], v111, s[8:11], s21 offen offset:64 sc1 nt
    buffer_store_dwordx4 v[238:241], v111, s[8:11], s21 offen offset:128 sc1 nt
    s_cmp_lg_u32 s19, 6
    s_nop 0
    s_cbranch_scc1 L_nodma2
L_end:
    s_endpgm
L_pads0:
    v_mov_b32 v205, 0xbe8ac140
    v_mov_b32 v206, 0x3f804140
    v_add_u32 v203, 0, v255
    v_mul_u32_u24 v202, 37, v203
    v_lshrrev_b32 v202, 8, v202
    v_mul_u32_u24 v204, 7, v202
    v_sub_u32 v203, v203, v204
    v_lshrrev_b32 v202, 2, v202
    v_lshrrev_b32 v203, 2, v203
    v_mul_u32_u24 v204, s34, v202
    v_mad_u32_u24 v204, v203, 0, v204
    v_cmp_eq_u32 s[44:45], v204, v162
    s_nop 1
    v_cndmask_b32_e64 v117, 0, v205, s[44:45]
    v_cndmask_b32_e64 v133, v206, 0, s[44:45]
    v_add_u32 v203, 16, v255
    v_mul_u32_u24 v202, 37, v203
    v_lshrrev_b32 v202, 8, v202
    v_mul_u32_u24 v204, 7, v202
    v_sub_u32 v203, v203, v204
    v_lshrrev_b32 v202, 2, v202
    v_lshrrev_b32 v203, 2, v203
    v_mul_u32_u24 v204, s34, v202
    v_mad_u32_u24 v204, v203, 0, v204
    v_cmp_eq_u32 s[44:45], v204, v162
    s_nop 1
    v_cndmask_b32_e64 v121, 0, v205, s[44:45]
    v_cndmask_b32_e64 v137, v206, 0, s[44:45]
    v_add_u32 v203, 32, v255
    v_mul_u32_u24 v202, 37, v203
    v_lshrrev_b32 v202, 8, v202
    v_mul_u32_u24 v204, 7, v202
    v_sub_u32 v203, v203, v204
    v_lshrrev_b32 v202, 2, v202
    v_lshrrev_b32 v203, 2, v203
    v_mul_u32_u24 v204, s34, v202
    v_mad_u32_u24 v204, v203, 0, v204
    v_cmp_eq_u32 s[44:45], v204, v162
    s_nop 1
    v_cndmask_b32_e64 v125, 0, v205, s[44:45]
    v_cndmask_b32_e64 v141, v206, 0, s[44:45]
    v_cmp_eq_u32 s[44:45], 5, v255
    v_mov_b32 v203, s35
    s_nop 0
    v_cndmask_b32_e64 v204, 0, v203, s[44:45]
    v_add_u32 v204, s34, v204
    v_cmp_eq_u32 s[44:45], v204, v162
    s_nop 1
    v_cndmask_b32_e64 v129, 0, v205, s[44:45]
    v_cndmask_b32_e64 v145, v206, 0, s[44:45]
    s_nop 1
    s_branch L_pads0r
L_slow0:
    ds_read_b128 v[178:181], v253
    ds_read_b128 v[182:185], v253 offset:1024
    ds_read_b128 v[186:189], v253 offset:2048
    ds_read_b32 v96, v96
    ds_read_b32 v102, v102
    ds_read_b32 v98, v98
    ds_read_b32 v104, v104
    ds_read_b32 v100, v100
    ds_read_b32 v106, v106
    ds_read_b32 v108, v108 offset:336
    ds_read2_b32 v[60:61], v60 offset0:84 offset1:83
    ds_read_b32 v62, v62 offset:328
    ds_read_b32 v63, v63 offset:324
    ds_read_b32 v64, v64 offset:272
    ds_read_b32 v65, v65 offset:268
    ds_read2_b32 v[66:67], v66 offset0:66 offset1:65
    ds_read2_b32 v[68:69], v68 offset0:52 offset1:51
    ds_read_b32 v70, v70 offset:200
    s_waitcnt lgkmcnt(15)
    v_mfma_f32_16x16x32_bf16 v[222:225], v[0:3], v[178:181], 0
    ds_read_b32 v71, v71 offset:196
    ds_read2_b32 v[72:73], v72 offset0:84 offset1:83
    v_mfma_f32_16x16x32_bf16 v[226:229], v[12:15], v[178:181], 0
    ds_read_b32 v74, v74 offset:328
    ds_read_b32 v75, v75 offset:324
    v_mfma_f32_16x16x32_bf16 v[230:233], v[24:27], v[178:181], 0
    ds_read_b32 v76, v76 offset:272
    ds_read_b32 v77, v77 offset:268
    v_mfma_f32_16x16x32_bf16 v[222:225], v[4:7], v[182:185], v[222:225]
    ds_read2_b32 v[78:79], v78 offset0:66 offset1:65
    ds_read2_b32 v[80:81], v80 offset0:52 offset1:51
    v_mfma_f32_16x16x32_bf16 v[226:229], v[16:19], v[182:185], v[226:229]
    ds_read_b32 v82, v82 offset:200
    ds_read_b32 v83, v83 offset:196
    v_mfma_f32_16x16x32_bf16 v[230:233], v[28:31], v[182:185], v[230:233]
    ds_read2_b32 v[84:85], v84 offset0:84 offset1:83
    ds_read_b32 v86, v86 offset:328
    v_mfma_f32_16x16x32_bf16 v[222:225], v[8:11], v[186:189], v[222:225]
    ds_read_b32 v87, v87 offset:324
    ds_read_b32 v88, v88 offset:272
    v_mfma_f32_16x16x32_bf16 v[226:229], v[20:23], v[186:189], v[226:229]
    ds_read_b32 v89, v89 offset:268
    ds_read2_b32 v[90:91], v90 offset0:66 offset1:65
    v_mfma_f32_16x16x32_bf16 v[238:241], v[178:181], v[48:51], 0
    ds_read2_b32 v[92:93], v92 offset0:52 offset1:51
    s_nop 0
    v_fma_f32 v250, v222, v222, s24
    v_mfma_f32_16x16x32_bf16 v[230:233], v[32:35], v[186:189], v[230:233]
    v_fma_f32 v251, v223, v223, s24
    v_fma_f32 v252, v226, v226, s24
    v_mfma_f32_16x16x32_bf16 v[234:237], v[178:181], v[36:39], 0
    v_fma_f32 v253, v227, v227, s24
    v_fmac_f32 v252, v228, v228
    v_mfma_f32_16x16x32_bf16 v[238:241], v[182:185], v[52:55], v[238:241]
    v_fmac_f32 v253, v229, v229
    v_fmac_f32 v250, v224, v224
    v_mfma_f32_16x16x32_bf16 v[234:237], v[182:185], v[40:43], v[234:237]
    v_fmac_f32 v251, v225, v225
    v_fmac_f32 v252, v232, v232
    v_mfma_f32_16x16x32_bf16 v[238:241], v[186:189], v[56:59], v[238:241]
    v_fmac_f32 v253, v233, v233
    v_fmac_f32 v250, v230, v230
    v_mfma_f32_16x16x32_bf16 v[234:237], v[186:189], v[44:47], v[234:237]
    v_fmac_f32 v251, v231, v231
    v_cvt_pk_bf16_f32 v245, v252, v253
    v_cvt_pk_bf16_f32 v244, v250, v251
    ds_read_b32 v94, v94 offset:200
    ds_read_b32 v95, v95 offset:196
    v_mfma_f32_16x16x16_bf16 v[250:253], v[112:113], v[244:245], 0
    v_cvt_pk_bf16_f32 v238, v238, v239
    v_cvt_pk_bf16_f32 v239, v240, v241
    v_cvt_pk_bf16_f32 v234, v234, v235
    v_cvt_pk_bf16_f32 v235, v236, v237
    v_or_b32 v238, v238, v154
    v_or_b32 v239, v239, v154
    s_mov_b32 exec_lo, 0xffffffff
    s_mov_b32 exec_hi, 0x0
    ds_write_b16 v168, v234 offset:256
    ds_write_b16_d16_hi v168, v234 offset:576
    ds_write_b16 v168, v238 offset:264
    ds_write_b16_d16_hi v168, v238 offset:584
    s_mov_b32 exec_lo, 0xffff
    s_mov_b32 exec_hi, 0x0
    ds_write_b16 v168, v235 offset:896
    ds_write_b16_d16_hi v168, v235 offset:1216
    ds_write_b16 v168, v239 offset:904
    ds_write_b16_d16_hi v168, v239 offset:1224
    s_mov_b64 exec, -1
    v_rsq_f32 v250, v250
    v_rsq_f32 v252, v252
    v_mul_f32 v250, s31, v250
    v_mul_f32 v226, v252, v226
    v_mul_f32 v227, v252, v227
    v_mul_f32 v228, v252, v228
    v_mul_f32 v229, v252, v229
    v_mul_f32 v232, v252, v232
    v_mul_f32 v233, v252, v233
    v_mul_f32 v222, v250, v222
    v_mul_f32 v223, v250, v223
    v_mul_f32 v224, v250, v224
    v_mul_f32 v225, v250, v225
    v_mul_f32 v230, v250, v230
    v_mul_f32 v231, v250, v231
    v_cvt_pk_bf16_f32 v142, v226, v227
    v_cvt_pk_bf16_f32 v143, v228, v229
    v_cvt_pk_bf16_f32 v144, v232, v233
    v_cvt_pk_bf16_f32 v126, v222, v223
    v_cvt_pk_bf16_f32 v127, v224, v225
    v_cvt_pk_bf16_f32 v128, v230, v231
    s_mov_b32 exec_lo, 0x3f003f
    s_mov_b32 exec_hi, 0x3f003f
    ds_write_b128 v165, v[126:129]
    ds_write_b128 v165, v[142:145] offset:64
    s_mov_b64 exec, -1
    s_waitcnt lgkmcnt(0)
    s_branch L_p1slow
L_pads5:
    s_cmp_eq_u32 s35, 0
    s_cbranch_scc1 L_pads5r
    v_mbcnt_lo_u32_b32 v178, -1, 0
    v_mbcnt_hi_u32_b32 v178, -1, v178
    v_and_b32 v179, 15, v178
    v_lshrrev_b32 v180, 4, v178
    v_mov_b32 v184, 0xbe8ac140
    v_mov_b32 v185, 0x3f804140
    v_add_u32 v182, 0, v179
    v_mul_u32_u24 v181, 37, v182
    v_lshrrev_b32 v181, 8, v181
    v_mul_u32_u24 v183, 7, v181
    v_sub_u32 v182, v182, v183
    v_lshrrev_b32 v181, 2, v181
    v_lshrrev_b32 v182, 2, v182
    v_mul_u32_u24 v183, s34, v181
    v_mad_u32_u24 v183, v182, s35, v183
    v_cmp_eq_u32 s[44:45], v183, v180
    s_nop 1
    v_cndmask_b32_e64 v117, 0, v184, s[44:45]
    v_cndmask_b32_e64 v133, v185, 0, s[44:45]
    v_add_u32 v182, 16, v179
    v_mul_u32_u24 v181, 37, v182
    v_lshrrev_b32 v181, 8, v181
    v_mul_u32_u24 v183, 7, v181
    v_sub_u32 v182, v182, v183
    v_lshrrev_b32 v181, 2, v181
    v_lshrrev_b32 v182, 2, v182
    v_mul_u32_u24 v183, s34, v181
    v_mad_u32_u24 v183, v182, s35, v183
    v_cmp_eq_u32 s[44:45], v183, v180
    s_nop 1
    v_cndmask_b32_e64 v121, 0, v184, s[44:45]
    v_cndmask_b32_e64 v137, v185, 0, s[44:45]
    v_add_u32 v182, 32, v179
    v_mul_u32_u24 v181, 37, v182
    v_lshrrev_b32 v181, 8, v181
    v_mul_u32_u24 v183, 7, v181
    v_sub_u32 v182, v182, v183
    v_lshrrev_b32 v181, 2, v181
    v_lshrrev_b32 v182, 2, v182
    v_mul_u32_u24 v183, s34, v181
    v_mad_u32_u24 v183, v182, s35, v183
    v_cmp_eq_u32 s[44:45], v183, v180
    s_nop 1
    v_cndmask_b32_e64 v125, 0, v184, s[44:45]
    v_cndmask_b32_e64 v141, v185, 0, s[44:45]
    s_nop 1
    s_branch L_pads5r
L_nodma2:
    v_mov_b32 v111, s76
    s_nop 1
    s_branch L_nodma
L_p1slow:
    ds_read_b128 v[178:181], v97
    ds_read_b128 v[182:185], v97 offset:1024
    ds_read_b128 v[186:189], v97 offset:2048
    ds_read_b128 v[190:193], v97 offset:3072
    ds_read_b128 v[194:197], v97 offset:4096
    ds_read_b128 v[198:201], v97 offset:5120
    ds_read_b128 v[126:129], v103
    ds_read_b128 v[142:145], v103 offset:64
    s_waitcnt lgkmcnt(7)
    v_mfma_f32_16x16x32_bf16 v[202:205], v[0:3], v[178:181], 0
    ds_read_b32 v162, v111
    ds_read_b32 v163, v111 offset:256
    v_mfma_f32_16x16x32_bf16 v[206:209], v[12:15], v[178:181], 0
    ds_read_b32 v164, v111 offset:512
    ds_read_u16 v160, v105 offset:264
    v_mfma_f32_16x16x32_bf16 v[210:213], v[24:27], v[178:181], 0
    ds_read_u16 v152, v105 offset:256
    s_waitcnt lgkmcnt(11)
    v_mfma_f32_16x16x32_bf16 v[202:205], v[4:7], v[182:185], v[202:205]
    v_mfma_f32_16x16x32_bf16 v[206:209], v[16:19], v[182:185], v[206:209]
    v_mfma_f32_16x16x32_bf16 v[210:213], v[28:31], v[182:185], v[210:213]
    s_waitcnt lgkmcnt(10)
    v_mfma_f32_16x16x32_bf16 v[202:205], v[8:11], v[186:189], v[202:205]
    v_mfma_f32_16x16x32_bf16 v[206:209], v[20:23], v[186:189], v[206:209]
    s_waitcnt lgkmcnt(4)
    buffer_load_dwordx4 v162, s[4:7], s22 offen lds
    s_add_u32 m0, m0, 1024
    v_mfma_f32_16x16x32_bf16 v[210:213], v[32:35], v[186:189], v[210:213]
    s_nop 2
    v_fma_f32 v246, v202, v202, s24
    v_fma_f32 v247, v203, v203, s24
    v_mfma_f32_16x16x32_bf16 v[214:217], v[178:181], v[36:39], 0
    v_fma_f32 v248, v206, v206, s24
    v_fma_f32 v249, v207, v207, s24
    v_mfma_f32_16x16x32_bf16 v[218:221], v[178:181], v[48:51], 0
    ds_read_b128 v[178:181], v97 offset:6144
    v_fmac_f32 v248, v208, v208
    v_mfma_f32_16x16x32_bf16 v[214:217], v[182:185], v[40:43], v[214:217]
    v_fmac_f32 v249, v209, v209
    v_fmac_f32 v246, v204, v204
    v_mfma_f32_16x16x32_bf16 v[218:221], v[182:185], v[52:55], v[218:221]
    v_fmac_f32 v247, v205, v205
    ds_read_b128 v[182:185], v97 offset:7168
    v_fmac_f32 v248, v212, v212
    v_fmac_f32 v249, v213, v213
    v_fmac_f32 v246, v210, v210
    v_fmac_f32 v247, v211, v211
    v_mfma_f32_16x16x32_bf16 v[214:217], v[186:189], v[44:47], v[214:217]
    v_cvt_pk_bf16_f32 v254, v246, v247
    v_cvt_pk_bf16_f32 v255, v248, v249
    v_mfma_f32_16x16x32_bf16 v[218:221], v[186:189], v[56:59], v[218:221]
    ds_read_b128 v[186:189], v97 offset:8192
    buffer_load_dwordx4 v162, s[4:7], s38 offen lds
    s_add_u32 m0, m0, 1024
    v_mfma_f32_16x16x16_bf16 v[246:249], v[112:113], v[254:255], 0
    s_nop 0
    v_cvt_pk_bf16_f32 v146, v214, v215
    v_cvt_pk_bf16_f32 v147, v216, v217
    v_mfma_f32_16x16x32_bf16 v[222:225], v[0:3], v[190:193], 0
    s_mov_b64 exec, s[26:27]
    v_cvt_pk_bf16_f32 v154, v218, v219
    v_cvt_pk_bf16_f32 v155, v220, v221
    s_mov_b64 exec, -1
    v_mfma_f32_16x16x32_bf16 v[226:229], v[12:15], v[190:193], 0
    v_rsq_f32 v246, v246
    v_rsq_f32 v248, v248
    v_mul_f32 v246, s31, v246
    v_mfma_f32_16x16x32_bf16 v[230:233], v[24:27], v[190:193], 0
    v_mul_f32 v206, v248, v206
    v_mul_f32 v207, v248, v207
    v_mul_f32 v208, v248, v208
    v_mul_f32 v209, v248, v209
    v_mul_f32 v202, v246, v202
    v_mul_f32 v203, v246, v203
    v_mul_f32 v204, v246, v204
    v_mul_f32 v205, v246, v205
    v_cvt_pk_bf16_f32 v130, v206, v207
    v_cvt_pk_bf16_f32 v131, v208, v209
    v_cvt_pk_bf16_f32 v114, v202, v203
    v_cvt_pk_bf16_f32 v115, v204, v205
    s_waitcnt lgkmcnt(2)
    v_mfma_f32_16x16x32_bf16 v[202:205], v[0:3], v[178:181], 0
    v_mul_f32 v212, v248, v212
    v_mul_f32 v213, v248, v213
    v_mfma_f32_16x16x32_bf16 v[206:209], v[12:15], v[178:181], 0
    v_mul_f32 v210, v246, v210
    v_mul_f32 v211, v246, v211
    v_cvt_pk_bf16_f32 v132, v212, v213
    v_cvt_pk_bf16_f32 v116, v210, v211
    v_mfma_f32_16x16x32_bf16 v[222:225], v[4:7], v[194:197], v[222:225]
    buffer_load_dwordx4 v162, s[4:7], s39 offen lds
    s_add_u32 m0, m0, 1024
    v_mfma_f32_16x16x32_bf16 v[226:229], v[16:19], v[194:197], v[226:229]
    v_mfma_f32_16x16x32_bf16 v[210:213], v[24:27], v[178:181], 0
    s_waitcnt lgkmcnt(1)
    v_mfma_f32_16x16x32_bf16 v[202:205], v[4:7], v[182:185], v[202:205]
    v_mfma_f32_16x16x32_bf16 v[206:209], v[16:19], v[182:185], v[206:209]
    v_mfma_f32_16x16x32_bf16 v[230:233], v[28:31], v[194:197], v[230:233]
    buffer_load_dwordx4 v163, s[4:7], s22 offen lds
    s_add_u32 m0, m0, 1024
    v_mfma_f32_16x16x32_bf16 v[222:225], v[8:11], v[198:201], v[222:225]
    v_mfma_f32_16x16x32_bf16 v[226:229], v[20:23], v[198:201], v[226:229]
    v_mfma_f32_16x16x32_bf16 v[210:213], v[28:31], v[182:185], v[210:213]
    s_nop 5
    v_fma_f32 v250, v222, v222, s24
    s_waitcnt lgkmcnt(0)
    v_mfma_f32_16x16x32_bf16 v[202:205], v[8:11], v[186:189], v[202:205]
    v_fma_f32 v251, v223, v223, s24
    v_fma_f32 v252, v226, v226, s24
    v_mfma_f32_16x16x32_bf16 v[206:209], v[20:23], v[186:189], v[206:209]
    v_fma_f32 v253, v227, v227, s24
    v_fmac_f32 v252, v228, v228
    v_mfma_f32_16x16x32_bf16 v[230:233], v[32:35], v[198:201], v[230:233]
    v_fmac_f32 v253, v229, v229
    s_nop 0
    v_fma_f32 v246, v202, v202, s24
    v_mfma_f32_16x16x32_bf16 v[210:213], v[32:35], v[186:189], v[210:213]
    v_fma_f32 v247, v203, v203, s24
    v_fma_f32 v248, v206, v206, s24
    v_fma_f32 v249, v207, v207, s24
    v_fmac_f32 v250, v224, v224
    v_fmac_f32 v251, v225, v225
    v_fmac_f32 v248, v208, v208
    v_fmac_f32 v249, v209, v209
    v_fmac_f32 v246, v204, v204
    v_fmac_f32 v247, v205, v205
    v_fmac_f32 v252, v232, v232
    v_fmac_f32 v253, v233, v233
    v_fmac_f32 v250, v230, v230
    v_fmac_f32 v251, v231, v231
    v_fmac_f32 v248, v212, v212
    v_fmac_f32 v249, v213, v213
    v_fmac_f32 v246, v210, v210
    v_fmac_f32 v247, v211, v211
    v_cvt_pk_bf16_f32 v244, v250, v251
    v_cvt_pk_bf16_f32 v245, v252, v253
    v_cvt_pk_bf16_f32 v254, v246, v247
    v_cvt_pk_bf16_f32 v255, v248, v249
    v_mfma_f32_16x16x16_bf16 v[250:253], v[112:113], v[244:245], 0
    buffer_load_dwordx4 v163, s[4:7], s38 offen lds
    s_add_u32 m0, m0, 1024
    v_mfma_f32_16x16x16_bf16 v[246:249], v[112:113], v[254:255], 0
    v_mfma_f32_16x16x32_bf16 v[214:217], v[178:181], v[36:39], 0
    s_nop 3
    v_rsq_f32 v252, v252
    v_mfma_f32_16x16x32_bf16 v[218:221], v[178:181], v[48:51], 0
    s_nop 0
    v_rsq_f32 v248, v248
    v_mfma_f32_16x16x32_bf16 v[234:237], v[190:193], v[36:39], 0
    v_mul_f32 v226, v252, v226
    v_mul_f32 v227, v252, v227
    v_mfma_f32_16x16x32_bf16 v[214:217], v[182:185], v[40:43], v[214:217]
    v_mul_f32 v228, v252, v228
    v_mul_f32 v229, v252, v229
    v_mfma_f32_16x16x32_bf16 v[218:221], v[182:185], v[52:55], v[218:221]
    v_mul_f32 v232, v252, v232
    v_mul_f32 v233, v252, v233
    v_mul_f32 v206, v248, v206
    v_mul_f32 v207, v248, v207
    v_mul_f32 v208, v248, v208
    v_mul_f32 v209, v248, v209
    v_mul_f32 v212, v248, v212
    v_mul_f32 v213, v248, v213
    v_mfma_f32_16x16x32_bf16 v[234:237], v[194:197], v[40:43], v[234:237]
    v_cvt_pk_bf16_f32 v134, v226, v227
    v_cvt_pk_bf16_f32 v135, v228, v229
    v_cvt_pk_bf16_f32 v136, v232, v233
    v_cvt_pk_bf16_f32 v138, v206, v207
    v_cvt_pk_bf16_f32 v139, v208, v209
    v_cvt_pk_bf16_f32 v140, v212, v213
    v_mfma_f32_16x16x32_bf16 v[214:217], v[186:189], v[44:47], v[214:217]
    v_rsq_f32 v250, v250
    v_mfma_f32_16x16x32_bf16 v[218:221], v[186:189], v[56:59], v[218:221]
    v_mul_f32 v250, s31, v250
    v_rsq_f32 v246, v246
    v_mfma_f32_16x16x32_bf16 v[238:241], v[190:193], v[48:51], 0
    v_mul_f32 v222, v250, v222
    v_mul_f32 v223, v250, v223
    v_mfma_f32_16x16x32_bf16 v[178:181], v[126:129], v[130:133], v[102:105]
    v_mul_f32 v224, v250, v224
    v_mul_f32 v225, v250, v225
    v_mfma_f32_16x16x32_bf16 v[182:185], v[126:129], v[134:137], v[104:107]
    v_cvt_pk_bf16_f32 v118, v222, v223
    v_cvt_pk_bf16_f32 v119, v224, v225
    v_mfma_f32_16x16x32_bf16 v[186:189], v[126:129], v[138:141], v[106:109]
    v_mul_f32 v230, v250, v230
    v_mul_f32 v231, v250, v231
    v_mfma_f32_16x16x32_bf16 v[234:237], v[198:201], v[44:47], v[234:237]
    v_cvt_pk_bf16_f32 v120, v230, v231
    buffer_load_dwordx4 v163, s[4:7], s39 offen lds
    s_add_u32 m0, m0, 1024
    v_mfma_f32_16x16x32_bf16 v[190:193], v[126:129], v[142:145], v[108:111]
    s_nop 0
    v_max3_f32 v180, v178, v182, v186
    v_mul_f32 v246, s31, v246
    v_mfma_f32_16x16x32_bf16 v[222:225], v[130:133], v[114:117], v[60:63]
    v_cvt_pk_bf16_f32 v148, v234, v235
    v_cvt_pk_bf16_f32 v149, v236, v237
    v_mfma_f32_16x16x32_bf16 v[234:237], v[142:145], v[114:117], v[96:99]
    v_mul_f32 v202, v246, v202
    v_max_f32 v180, v180, v190
    v_mfma_f32_16x16x32_bf16 v[226:229], v[134:137], v[114:117], v[64:67]
    s_nop 0
    v_max_f32_dpp v181, v180, v180 row_ror:8 row_mask:0xf bank_mask:0xf
    v_mul_f32 v203, v246, v203
    v_mov_b32 v180, v181
    v_mfma_f32_16x16x32_bf16 v[230:233], v[138:141], v[114:117], v[68:71]
    s_nop 0
    v_max_f32_dpp v181, v180, v180 row_ror:4 row_mask:0xf bank_mask:0xf
    v_max3_f32 v235, v222, v223, v224
    v_mov_b32 v180, v181
    buffer_load_dwordx4 v164, s[4:7], s22 offen lds
    s_add_u32 m0, m0, 1024
    v_max3_f32 v235, v235, v225, v226
    v_max_f32_dpp v181, v180, v180 row_ror:2 row_mask:0xf bank_mask:0xf
    v_max3_f32 v235, v235, v227, v228
    v_mov_b32 v180, v181
    v_max3_f32 v235, v235, v229, v230
    v_mul_f32 v204, v246, v204
    v_max_f32_dpp v181, v180, v180 row_ror:1 row_mask:0xf bank_mask:0xf
    v_max3_f32 v235, v235, v231, v232
    v_mov_b32 v180, v181
    v_max3_f32 v235, v235, v233, v234
    v_sub_f32 v178, v178, v180
    v_sub_f32 v182, v182, v180
    v_mov_b32 v236, v235
    v_sub_f32 v186, v186, v180
    v_sub_f32 v190, v190, v180
    v_exp_f32 v178, v178
    v_exp_f32 v182, v182
    v_permlane32_swap_b32 v236, v235
    v_exp_f32 v190, v190
    v_exp_f32 v186, v186
    v_cvt_pk_bf16_f32 v179, v178, v182
    v_max_f32 v235, v235, v236
    v_cvt_pk_bf16_f32 v183, v186, v190
    ds_write_b16 v105, v179 offset:128
    v_mov_b32 v236, v235
    ds_write_b16_d16_hi v105, v179 offset:136
    v_mul_f32 v205, v246, v205
    ds_write_b16 v105, v183 offset:192
    v_permlane16_swap_b32 v236, v235
    ds_write_b16_d16_hi v105, v183 offset:200
    v_max_f32 v235, v235, v236
    ds_read_b128 v[170:173], v103 offset:128
    v_sub_f32 v222, v222, v235
    v_sub_f32 v223, v223, v235
    v_sub_f32 v224, v224, v235
    ds_read_b128 v[174:177], v103 offset:192
    v_sub_f32 v225, v225, v235
    v_sub_f32 v234, v234, v235
    v_mul_f32 v210, v246, v210
    v_mul_f32 v211, v246, v211
    v_sub_f32 v226, v226, v235
    v_sub_f32 v227, v227, v235
    v_sub_f32 v228, v228, v235
    v_sub_f32 v229, v229, v235
    v_exp_f32 v222, v222
    v_exp_f32 v223, v223
    v_exp_f32 v224, v224
    v_exp_f32 v225, v225
    v_exp_f32 v234, v234
    buffer_load_dwordx4 v164, s[4:7], s38 offen lds
    s_add_u32 m0, m0, 1024
    v_cvt_pk_bf16_f32 v122, v202, v203
    v_cvt_pk_bf16_f32 v123, v204, v205
    v_cvt_pk_bf16_f32 v124, v210, v211
    v_exp_f32 v226, v226
    v_exp_f32 v227, v227
    v_exp_f32 v228, v228
    v_exp_f32 v229, v229
    v_mfma_f32_16x16x32_bf16 v[238:241], v[194:197], v[52:55], v[238:241]
    v_sub_f32 v230, v230, v235
    v_sub_f32 v231, v231, v235
    v_sub_f32 v232, v232, v235
    v_sub_f32 v233, v233, v235
    v_cvt_pk_bf16_f32 v162, v222, v223
    buffer_load_dwordx4 v164, s[4:7], s39 offen lds
    s_add_u32 m0, m0, 1024
    v_cvt_pk_bf16_f32 v163, v224, v225
    v_cvt_pk_bf16_f32 v168, v234, 0
    v_mfma_f32_16x16x32_bf16 v[178:181], v[130:133], v[118:121], v[72:75]
    v_cvt_pk_bf16_f32 v164, v226, v227
    v_cvt_pk_bf16_f32 v165, v228, v229
    v_mfma_f32_16x16x32_bf16 v[222:225], v[130:133], v[122:125], v[84:87]
    v_exp_f32 v230, v230
    v_exp_f32 v231, v231
    v_exp_f32 v232, v232
    v_exp_f32 v233, v233
    v_mfma_f32_16x16x32_bf16 v[190:193], v[142:145], v[118:121], v[98:101]
    v_cvt_pk_bf16_f32 v166, v230, v231
    v_cvt_pk_bf16_f32 v167, v232, v233
    v_mfma_f32_16x16x32_bf16 v[234:237], v[142:145], v[122:125], v[100:103]
    s_mov_b64 exec, s[26:27]
    v_cvt_pk_bf16_f32 v158, v218, v219
    v_cvt_pk_bf16_f32 v159, v220, v221
    s_mov_b64 exec, -1
    v_mfma_f32_16x16x32_bf16 v[238:241], v[198:201], v[56:59], v[238:241]
    v_max3_f32 v191, v178, v179, v180
    v_cvt_pk_bf16_f32 v150, v214, v215
    v_mfma_f32_16x16x32_bf16 v[182:185], v[134:137], v[118:121], v[76:79]
    v_max3_f32 v235, v222, v223, v224
    v_cvt_pk_bf16_f32 v151, v216, v217
    v_mfma_f32_16x16x32_bf16 v[226:229], v[134:137], v[122:125], v[88:91]
    s_mov_b64 exec, s[26:27]
    s_nop 0
    v_cvt_pk_bf16_f32 v156, v238, v239
    v_cvt_pk_bf16_f32 v157, v240, v241
    s_mov_b64 exec, -1
    v_mfma_f32_16x16x32_bf16 v[186:189], v[138:141], v[118:121], v[80:83]
    v_max3_f32 v191, v191, v181, v182
    v_mfma_f32_16x16x32_bf16 v[230:233], v[138:141], v[122:125], v[92:95]
    v_max3_f32 v235, v235, v225, v226
    v_max3_f32 v191, v191, v183, v184
    v_max3_f32 v235, v235, v227, v228
    s_waitcnt lgkmcnt(1)
    v_mfma_f32_16x16x32_bf16 v[242:245], v[154:157], v[170:173], 0
    s_nop 0
    v_max3_f32 v191, v191, v185, v186
    v_max3_f32 v191, v191, v187, v188
    v_mfma_f32_16x16x32_bf16 v[238:241], v[146:149], v[170:173], 0
    v_max3_f32 v235, v235, v229, v230
    v_max3_f32 v191, v191, v189, v190
    v_max3_f32 v235, v235, v231, v232
    s_waitcnt lgkmcnt(0)
    v_mfma_f32_16x16x32_bf16 v[242:245], v[158:161], v[174:177], v[242:245]
    v_max3_f32 v235, v235, v233, v234
    v_mov_b32 v192, v191
    v_mov_b32 v236, v235
    v_mfma_f32_16x16x32_bf16 v[198:201], v[154:157], v[162:165], 0
    v_permlane32_swap_b32 v192, v191
    v_permlane32_swap_b32 v236, v235
    v_mfma_f32_16x16x32_bf16 v[238:241], v[150:153], v[174:177], v[238:241]
    v_max_f32 v191, v191, v192
    v_max_f32 v235, v235, v236
    v_mfma_f32_16x16x32_bf16 v[198:201], v[158:161], v[166:169], v[198:201]
    v_mov_b32 v192, v191
    v_mov_b32 v236, v235
    v_mfma_f32_16x16x32_bf16 v[194:197], v[146:149], v[162:165], 0
    v_rcp_f32 v244, v244
    v_permlane16_swap_b32 v192, v191
    v_permlane16_swap_b32 v236, v235
    v_mfma_f32_16x16x32_bf16 v[194:197], v[150:153], v[166:169], v[194:197]
    v_max_f32 v191, v191, v192
    v_max_f32 v235, v235, v236
    v_mul_f32 v238, v244, v238
    v_mul_f32 v239, v244, v239
    v_rcp_f32 v200, v200
    v_mul_f32 v240, v244, v240
    v_mul_f32 v241, v244, v241
    v_sub_f32 v178, v178, v191
    v_sub_f32 v179, v179, v191
    v_sub_f32 v180, v180, v191
    v_sub_f32 v181, v181, v191
    v_sub_f32 v182, v182, v191
    v_sub_f32 v183, v183, v191
    v_sub_f32 v184, v184, v191
    v_sub_f32 v185, v185, v191
    v_sub_f32 v222, v222, v235
    v_sub_f32 v223, v223, v235
    v_sub_f32 v224, v224, v235
    v_sub_f32 v225, v225, v235
    v_sub_f32 v226, v226, v235
    v_sub_f32 v227, v227, v235
    v_sub_f32 v228, v228, v235
    v_sub_f32 v229, v229, v235
    v_mul_f32 v242, v244, v242
    v_mul_f32 v243, v244, v243
    v_cvt_pk_bf16_f32 v238, v238, v239
    v_cvt_pk_bf16_f32 v239, v240, v241
    v_exp_f32 v178, v178
    v_exp_f32 v179, v179
    v_exp_f32 v180, v180
    v_exp_f32 v181, v181
    v_exp_f32 v182, v182
    v_exp_f32 v183, v183
    v_exp_f32 v184, v184
    v_exp_f32 v185, v185
    v_exp_f32 v222, v222
    v_exp_f32 v223, v223
    v_exp_f32 v224, v224
    v_exp_f32 v225, v225
    v_exp_f32 v226, v226
    v_exp_f32 v227, v227
    v_exp_f32 v228, v228
    v_exp_f32 v229, v229
    v_cvt_pk_bf16_f32 v242, v242, v243
    v_add_u32 v240, s33, v99
    v_add_u32 v241, s33, v101
    v_mul_f32 v198, v200, v198
    v_mul_f32 v199, v200, v199
    v_sub_f32 v186, v186, v191
    v_sub_f32 v187, v187, v191
    v_sub_f32 v188, v188, v191
    v_sub_f32 v189, v189, v191
    v_sub_f32 v190, v190, v191
    v_sub_f32 v230, v230, v235
    v_sub_f32 v231, v231, v235
    v_sub_f32 v232, v232, v235
    v_sub_f32 v233, v233, v235
    v_sub_f32 v234, v234, v235
    s_mov_b64 exec, s[42:43]
    ds_write_b64 v240, v[238:239]
    ds_write_b32 v241, v242
    s_mov_b64 exec, -1
    v_cvt_pk_bf16_f32 v198, v198, v199
    v_exp_f32 v190, v190
    v_cvt_pk_bf16_f32 v170, v178, v179
    v_cvt_pk_bf16_f32 v171, v180, v181
    v_cvt_pk_bf16_f32 v172, v182, v183
    v_cvt_pk_bf16_f32 v173, v184, v185
    v_exp_f32 v186, v186
    v_exp_f32 v187, v187
    v_exp_f32 v188, v188
    v_exp_f32 v189, v189
    v_exp_f32 v234, v234
    v_cvt_pk_bf16_f32 v162, v222, v223
    v_cvt_pk_bf16_f32 v163, v224, v225
    v_cvt_pk_bf16_f32 v164, v226, v227
    v_cvt_pk_bf16_f32 v165, v228, v229
    v_exp_f32 v230, v230
    v_exp_f32 v231, v231
    v_exp_f32 v232, v232
    v_exp_f32 v233, v233
    v_mul_f32 v194, v200, v194
    v_mul_f32 v195, v200, v195
    v_mul_f32 v196, v200, v196
    v_mul_f32 v197, v200, v197
    ds_write_b32 v101, v198
    v_cvt_pk_bf16_f32 v194, v194, v195
    v_mfma_f32_16x16x32_bf16 v[242:245], v[154:157], v[170:173], 0
    v_cvt_pk_bf16_f32 v195, v196, v197
    v_cvt_pk_bf16_f32 v176, v190, 0
    v_mfma_f32_16x16x32_bf16 v[198:201], v[154:157], v[162:165], 0
    v_cvt_pk_bf16_f32 v174, v186, v187
    v_cvt_pk_bf16_f32 v175, v188, v189
    v_cvt_pk_bf16_f32 v168, v234, 0
    v_cvt_pk_bf16_f32 v166, v230, v231
    v_cvt_pk_bf16_f32 v167, v232, v233
    ds_write_b64 v99, v[194:195]
    v_mfma_f32_16x16x32_bf16 v[238:241], v[146:149], v[170:173], 0
    v_mfma_f32_16x16x32_bf16 v[242:245], v[158:161], v[174:177], v[242:245]
    v_mfma_f32_16x16x32_bf16 v[194:197], v[146:149], v[162:165], 0
    v_mfma_f32_16x16x32_bf16 v[198:201], v[158:161], v[166:169], v[198:201]
    s_nop 5
    v_rcp_f32 v244, v244
    v_mfma_f32_16x16x32_bf16 v[238:241], v[150:153], v[174:177], v[238:241]
    v_mul_f32 v242, v244, v242
    v_mul_f32 v243, v244, v243
    v_mfma_f32_16x16x32_bf16 v[194:197], v[150:153], v[166:169], v[194:197]
    v_rcp_f32 v200, v200
    v_cvt_pk_bf16_f32 v242, v242, v243
    v_mul_f32 v198, v200, v198
    s_nop 1
    v_mul_f32 v238, v244, v238
    v_mul_f32 v239, v244, v239
    v_mul_f32 v240, v244, v240
    v_mul_f32 v241, v244, v241
    v_mul_f32 v194, v200, v194
    v_mul_f32 v195, v200, v195
    v_mul_f32 v199, v200, v199
    v_mul_f32 v196, v200, v196
    v_mul_f32 v197, v200, v197
    v_cvt_pk_bf16_f32 v238, v238, v239
    v_cvt_pk_bf16_f32 v194, v194, v195
    v_cvt_pk_bf16_f32 v239, v240, v241
    v_cvt_pk_bf16_f32 v198, v198, v199
    v_cvt_pk_bf16_f32 v195, v196, v197
    ds_write_b32 v101, v242 offset:3072
    ds_write_b64 v99, v[238:239] offset:3072
    ds_write_b32 v101, v198 offset:6144
    ds_write_b64 v99, v[194:195] offset:6144
    s_waitcnt vmcnt(0)
    s_waitcnt lgkmcnt(0)
    s_branch L_p1done
.section .rodata,"a"
.p2align 6
.amdhsa_kernel standalone__window_attn_swin_v2__vision_kernel
  .amdhsa_next_free_vgpr 256
  .amdhsa_next_free_sgpr 80
  .amdhsa_accum_offset 256
  .amdhsa_group_segment_fixed_size 0
  .amdhsa_kernarg_size 96
  .amdhsa_user_sgpr_count 2
  .amdhsa_user_sgpr_kernarg_segment_ptr 1
  .amdhsa_system_sgpr_workgroup_id_x 1
.end_amdhsa_kernel
```
